```python
import torch

def _softmax(x, axis=-1):
    return torch.softmax(x, dim=axis)
def _gelu(x):
    return torch.nn.functional.gelu(x, approximate="tanh")
def _silu(x):
    return torch.nn.functional.silu(x)
def _sigmoid(x):
    return torch.sigmoid(x)
def _layernorm(x, axis=-1, eps=1e-5):
    m = x.mean(dim=axis, keepdim=True)
    v = x.var(dim=axis, keepdim=True, unbiased=False)
    return (x - m) / torch.sqrt(v + eps)
def _scatter_add(tgt, idx, src, axis=0):
    return tgt.clone().index_add_(axis, idx, src)
def _segment_sum(src, seg, n):
    out = torch.zeros((n,) + src.shape[1:], dtype=src.dtype)
    return out.index_add_(0, seg, src)
def _pad(x, pw):
    flat = tuple(v for pair in reversed(pw) for v in pair)
    return torch.nn.functional.pad(x, flat)

kernel_name = 'sequential_preLN__sliding_block_cached__mixer_token_mlp__decode'

def setup_inputs():

    _w = (lambda a: (lambda t: t.to(torch.bfloat16) if t.is_floating_point() else t)(torch.as_tensor(a)))
    def _A_setup():
        B, Sq, D = 4, 1, 512
        Hq, Hkv, Sk, Dh = 32, 8, 8192, 128
        assert Hq % Hkv == 0, (Hq, Hkv)
        return {
            "x": _w((lambda *s: torch.randn(*s, dtype=torch.bfloat16) * 0.05)(B, Sq, D)),
            "k_cache": _w((lambda *s: torch.randn(*s, dtype=torch.bfloat16) * 3.2)(B, Hkv, Sk, Dh)),
            "v_cache": _w((lambda *s: torch.randn(*s, dtype=torch.bfloat16) * 0.8)(B, Hkv, Sk, Dh)),
            "wq": _w((lambda *s: torch.randn(*s, dtype=torch.bfloat16) * 3.2)(D, Hq * Dh) * (D ** -0.5)),
            "wo": _w((lambda *s: torch.randn(*s, dtype=torch.bfloat16) * 0.8)(Hq * Dh, D) * ((Hq * Dh) ** -0.5)),
        }
    _A_in = _A_setup()

    def _B_setup():
        B, S, D, F = 4, 1, 512, 1792
        return {
            "x": _w((lambda *s: torch.randn(*s, dtype=torch.bfloat16) * 0.05)(B, S, D)),
            "w1": _w((lambda *s: torch.randn(*s, dtype=torch.bfloat16) * 1.6)(S, F) * (S ** -0.5)),
            "b1": _w((lambda *s: torch.randn(*s, dtype=torch.bfloat16) * 1.6)(F) * 0.02),
            "w2": _w((lambda *s: torch.randn(*s, dtype=torch.bfloat16) * 1.6)(F, S) * (F ** -0.5)),
            "b2": _w((lambda *s: torch.randn(*s, dtype=torch.bfloat16) * 0.8)(S) * 0.02),
        }
    _B_in = _B_setup()

    return {
        "A_x": _A_in["x"],
        "A_k_cache": _A_in["k_cache"],
        "A_v_cache": _A_in["v_cache"],
        "A_wq": _A_in["wq"],
        "A_wo": _A_in["wo"],
        "B_x": _B_in["x"],
        "B_w1": _B_in["w1"],
        "B_b1": _B_in["b1"],
        "B_w2": _B_in["w2"],
        "B_b2": _B_in["b2"],
    }

def reference(A_x, A_k_cache, A_v_cache, A_wq, A_wo, B_x, B_w1, B_b1, B_w2, B_b2):
    def _A_ref(x, k_cache, v_cache, wq, wo):
        B, Sq, D = x.shape
        Hq, Dh = 32, 128
        Hkv, Sk = k_cache.shape[1], k_cache.shape[2]
        W = min(4096, max(256, Sk // 4))
        rep = Hq // Hkv
        q = (lambda x, *d: x.permute(*d))((x @ wq).reshape(B, Sq, Hq, Dh), 0, 2, 1, 3)
        k = (lambda x, n, axis: torch.repeat_interleave(x, n, dim=axis))(k_cache[:, :, Sk - W:, :], rep, axis=1)
        v = (lambda x, n, axis: torch.repeat_interleave(x, n, dim=axis))(v_cache[:, :, Sk - W:, :], rep, axis=1)
        scores = torch.einsum("bhqd,bhkd->bhqk", q, k) * (Dh ** -0.5)
        p = _softmax(scores, axis=-1)
        o = torch.einsum("bhqk,bhkd->bhqd", p, v)
        return (lambda x, *d: x.permute(*d))(o, 0, 2, 1, 3).reshape(B, Sq, Hq * Dh) @ wo

    def _B_ref(x, w1, b1, w2, b2):
        B, S, D = x.shape
        h = _layernorm(x, axis=-1)
        u = torch.einsum("bsd,sf->bdf", h, w1) + b1
        u = _gelu(u)
        y = torch.einsum("bdf,fs->bds", u, w2) + b2
        return (lambda x, *d: x.permute(*d))(y, 0, 2, 1)

    x = A_x
    h = x + _A_ref(_layernorm(x, axis=-1), A_k_cache, A_v_cache, A_wq, A_wo)
    h2 = h + _B_ref(_layernorm(h, axis=-1), B_w1, B_b1, B_w2, B_b2)
    return h2
```

```asm
; @launch grid=(256,1,1) block=(768,1,1) lds=122880
.amdgcn_target "amdgcn-amd-amdhsa--gfx950"
.text
.globl sequential_preLN__sliding_block_cached__mixer_token_mlp__decode_kernel
.p2align 8
.type sequential_preLN__sliding_block_cached__mixer_token_mlp__decode_kernel,@function
sequential_preLN__sliding_block_cached__mixer_token_mlp__decode_kernel:
    s_cmp_ge_u32 s2, 256
    s_cbranch_scc1 L_end
    s_load_dwordx16 s[16:31], s[0:1], 0
    s_load_dwordx8 s[32:39], s[0:1], 64
    s_load_dwordx2 s[40:41], s[0:1], 96
    v_lshrrev_b32 v4, 6, v0
    v_and_b32 v1, 63, v0
    v_readfirstlane_b32 s3, v4
    v_and_b32 v2, 15, v1
    v_lshrrev_b32 v3, 4, v1
    s_and_b32 s4, s2, 7
    s_lshr_b32 s5, s2, 3
    s_lshr_b32 s6, s5, 3
    s_and_b32 s7, s5, 7
    s_mov_b32 s42, 0xffff0000
    s_mov_b64 s[98:99], -1
    v_mov_b32 v163, 43456
    v_mov_b32 v162, 1
    v_mov_b32 v160, 0
    s_and_b32 s15, s3, 3
    s_lshl_b32 s8, s6, 3
    s_add_u32 s8, s8, s4
    s_lshl_b32 s8, s8, 21
    s_lshl_b32 s9, s7, 12
    s_add_u32 s8, s8, s9
    s_add_u32 s8, s8, 0x180000
    s_add_u32 s9, s2, s5
    s_mul_i32 s9, s9, 1
    s_add_u32 s9, s9, s15
    s_lshl_b32 s11, s15, 2
    v_add_u32 v164, s11, v163
    s_add_u32 s64, s9, 0
    s_and_b32 s64, s64, 15
    s_lshl_b32 s64, s64, 15
    s_add_u32 s64, s64, s8
    s_add_u32 s65, s9, 4
    s_and_b32 s65, s65, 15
    s_lshl_b32 s65, s65, 15
    s_add_u32 s65, s65, s8
    s_add_u32 s66, s9, 8
    s_and_b32 s66, s66, 15
    s_lshl_b32 s66, s66, 15
    s_add_u32 s66, s66, s8
    s_add_u32 s67, s9, 12
    s_and_b32 s67, s67, 15
    s_lshl_b32 s67, s67, 15
    s_add_u32 s67, s67, s8
    s_waitcnt lgkmcnt(0)
    s_mov_b32 s44, s40
    s_and_b32 s45, s41, 0xffff
    s_mov_b32 s46, 0x10000000
    s_mov_b32 s47, 0x20000
    s_load_dword s94, s[40:41], 0
    s_getreg_b32 s0, hwreg(HW_REG_XCC_ID)
    s_and_b32 s0, s0, 7
    s_cmp_eq_u32 s4, 4
    s_cselect_b32 s26, s5, 64
    s_cmp_ge_u32 s3, 8
    s_cbranch_scc1 L_V
    s_cmp_ge_u32 s3, 4
    s_cbranch_scc1 L_K
    s_mov_b32 s60, s34
    s_and_b32 s61, s35, 0xffff
    s_mov_b32 s62, 0x2
    s_mov_b32 s63, 0x20000
    buffer_load_ushort v145, v160, s[60:63], 0 offen
    s_cmp_lg_u32 s3, 0
    s_cbranch_scc1 L_C123
    s_mov_b32 s48, s16
    s_and_b32 s49, s17, 0xffff
    s_mov_b32 s50, 0x1000
    s_mov_b32 s51, 0x20000
    s_mov_b32 s52, s22
    s_and_b32 s53, s23, 0xffff
    s_mov_b32 s54, 0x400000
    s_mov_b32 s55, 0x20000
    v_and_b32 v4, 3, v1
    v_lshlrev_b32 v5, 10, v4
    v_lshrrev_b32 v6, 2, v1
    v_lshl_add_u32 v6, v6, 6, v5
    buffer_load_dwordx4 v[16:19], v6, s[48:51], 0 offen offset:0
    buffer_load_dwordx4 v[20:23], v6, s[48:51], 0 offen offset:16
    buffer_load_dwordx4 v[24:27], v6, s[48:51], 0 offen offset:32
    buffer_load_dwordx4 v[28:31], v6, s[48:51], 0 offen offset:48
    v_lshrrev_b32 v7, 2, v2
    v_lshl_add_u32 v5, v7, 6, v5
    v_lshl_add_u32 v5, v3, 3, v5
    s_lshl_b32 s8, s6, 8
    buffer_load_dwordx2 v[32:33], v5, s[48:51], s8 offen
    buffer_load_dwordx2 v[34:35], v5, s[48:51], s8 offen offset:32
    v_lshrrev_b32 v6, 3, v1
    v_lshlrev_b32 v6, 13, v6
    v_and_b32 v8, 7, v1
    v_lshlrev_b32 v9, 1, v3
    v_xor_b32 v8, v8, v9
    v_lshl_add_u32 v6, v8, 4, v6
    s_lshl_b32 s8, s6, 20
    s_lshl_b32 s9, s4, 10
    s_add_u32 s8, s8, s9
    s_lshl_b32 s9, s7, 7
    s_add_u32 s8, s8, s9
    s_mov_b32 m0, 0
    s_add_u32 s9, s8, 0x0
    buffer_load_dwordx4 v6, s[52:55], s9 offen nt lds
    s_mov_b32 m0, 1024
    s_add_u32 s9, s8, 0x10000
    buffer_load_dwordx4 v6, s[52:55], s9 offen nt lds
    s_mov_b32 m0, 2048
    s_add_u32 s9, s8, 0x20000
    buffer_load_dwordx4 v6, s[52:55], s9 offen nt lds
    s_mov_b32 m0, 3072
    s_add_u32 s9, s8, 0x30000
    buffer_load_dwordx4 v6, s[52:55], s9 offen nt lds
    s_mov_b32 m0, 4096
    s_add_u32 s9, s8, 0x40000
    buffer_load_dwordx4 v6, s[52:55], s9 offen nt lds
    s_mov_b32 m0, 5120
    s_add_u32 s9, s8, 0x50000
    buffer_load_dwordx4 v6, s[52:55], s9 offen nt lds
    s_mov_b32 m0, 6144
    s_add_u32 s9, s8, 0x60000
    buffer_load_dwordx4 v6, s[52:55], s9 offen nt lds
    s_mov_b32 m0, 7168
    s_add_u32 s9, s8, 0x70000
    buffer_load_dwordx4 v6, s[52:55], s9 offen nt lds
    s_mov_b32 m0, 8192
    s_add_u32 s9, s8, 0x80000
    buffer_load_dwordx4 v6, s[52:55], s9 offen nt lds
    s_mov_b32 m0, 9216
    s_add_u32 s9, s8, 0x90000
    buffer_load_dwordx4 v6, s[52:55], s9 offen nt lds
    s_mov_b32 m0, 10240
    s_add_u32 s9, s8, 0xa0000
    buffer_load_dwordx4 v6, s[52:55], s9 offen nt lds
    s_mov_b32 m0, 11264
    s_add_u32 s9, s8, 0xb0000
    buffer_load_dwordx4 v6, s[52:55], s9 offen nt lds
    s_mov_b32 m0, 12288
    s_add_u32 s9, s8, 0xc0000
    buffer_load_dwordx4 v6, s[52:55], s9 offen nt lds
    s_mov_b32 m0, 13312
    s_add_u32 s9, s8, 0xd0000
    buffer_load_dwordx4 v6, s[52:55], s9 offen nt lds
    s_mov_b32 m0, 14336
    s_add_u32 s9, s8, 0xe0000
    buffer_load_dwordx4 v6, s[52:55], s9 offen nt lds
    s_mov_b32 m0, 15360
    s_add_u32 s9, s8, 0xf0000
    buffer_load_dwordx4 v6, s[52:55], s9 offen nt lds
    s_barrier
    s_branch L_Q2
L_K:
    s_mov_b32 s48, s18
    s_and_b32 s49, s19, 0xffff
    s_mov_b32 s50, 0x4000000
    s_mov_b32 s51, 0x20000
    v_xor_b32 v4, v2, v3
    v_lshlrev_b32 v7, 8, v3
    v_lshlrev_b32 v9, 8, v2
    s_lshl_b32 s63, s15, 14
    s_add_u32 s63, s63, 57344
    v_add_u32 v9, s63, v9
    v_xor_b32 v8, 0, v4
    v_lshl_add_u32 v132, v8, 4, v7
    v_lshl_add_u32 v136, v8, 4, v9
    v_xor_b32 v8, 4, v4
    v_lshl_add_u32 v133, v8, 4, v7
    v_lshl_add_u32 v137, v8, 4, v9
    v_xor_b32 v8, 8, v4
    v_lshl_add_u32 v134, v8, 4, v7
    v_lshl_add_u32 v138, v8, 4, v9
    v_xor_b32 v8, 12, v4
    v_lshl_add_u32 v135, v8, 4, v7
    v_lshl_add_u32 v139, v8, 4, v9
    s_lshl_b32 s8, s4, 16
    s_lshl_b32 s9, s6, 14
    s_add_u32 s8, s8, s9
    s_lshl_b32 s9, s15, 10
    s_add_u32 s8, s8, s9
    s_add_u32 s12, s8, 0x90000
    s_add_u32 s13, s12, 0x1000
    s_add_u32 s14, s12, 0x2000
    s_add_u32 s43, s12, 0x3000
    s_lshl_b32 s68, s15, 9
    s_add_u32 s68, s68, 0x1000
    v_lshlrev_b32 v5, 4, v1
    v_add_u32 v5, 0x80000, v5
    v_lshlrev_b32 v6, 3, v1
    s_setprio 2
    s_barrier
    s_add_u32 m0, s63, 0
    s_nop 0
    buffer_load_dwordx4 v132, s[48:51], s64 offen offset:0 nt lds
    buffer_load_dwordx4 v133, s[48:51], s64 offen offset:1024 nt lds
    buffer_load_dwordx4 v134, s[48:51], s64 offen offset:2048 nt lds
    buffer_load_dwordx4 v135, s[48:51], s64 offen offset:3072 nt lds
    s_waitcnt vmcnt(3)
    s_add_u32 m0, s63, 4096
    s_nop 0
    buffer_load_dwordx4 v132, s[48:51], s65 offen offset:0 nt lds
    s_waitcnt vmcnt(3)
    buffer_load_dwordx4 v133, s[48:51], s65 offen offset:1024 nt lds
    s_waitcnt vmcnt(3)
    buffer_load_dwordx4 v134, s[48:51], s65 offen offset:2048 nt lds
    s_waitcnt vmcnt(3)
    buffer_load_dwordx4 v135, s[48:51], s65 offen offset:3072 nt lds
    s_waitcnt vmcnt(3)
    s_add_u32 m0, s63, 8192
    s_nop 0
    buffer_load_dwordx4 v132, s[48:51], s66 offen offset:0 nt lds
    s_waitcnt vmcnt(3)
    buffer_load_dwordx4 v133, s[48:51], s66 offen offset:1024 nt lds
    s_waitcnt vmcnt(3)
    buffer_load_dwordx4 v134, s[48:51], s66 offen offset:2048 nt lds
    buffer_load_dwordx4 v[80:83], v5, s[44:47], s12 offen sc1
    buffer_load_dwordx4 v[84:87], v5, s[44:47], s13 offen sc1
    buffer_load_dwordx4 v[88:91], v5, s[44:47], s14 offen sc1
    buffer_load_dwordx4 v[92:95], v5, s[44:47], s43 offen sc1
    s_waitcnt vmcnt(7)
    buffer_load_dwordx4 v135, s[48:51], s66 offen offset:3072 nt lds
    s_waitcnt vmcnt(7)
    s_add_u32 m0, s63, 12288
    s_nop 0
    buffer_load_dwordx4 v132, s[48:51], s67 offen offset:0 nt lds
    s_waitcnt vmcnt(7)
    buffer_load_dwordx4 v133, s[48:51], s67 offen offset:1024 nt lds
    s_mov_b64 exec, 1
    ds_add_u32 v164, v162 offset:16
    s_mov_b64 exec, -1
    s_waitcnt vmcnt(7)
    buffer_load_dwordx4 v134, s[48:51], s67 offen offset:2048 nt lds
    s_waitcnt vmcnt(3)
    buffer_load_dwordx4 v135, s[48:51], s67 offen offset:3072 nt lds
    s_waitcnt lgkmcnt(0)
    s_mul_i32 s92, s94, 0x85ebca6b
    s_add_u32 s92, s92, 0x7f4a7c15
    s_mul_i32 s93, s94, 0x9e3779b1
    s_add_u32 s93, s93, 0x1b873593
    s_mov_b32 s71, 0
    s_waitcnt vmcnt(5)
    s_branch L_qchk
L_qpoll:
    s_cmp_lg_u32 s71, 8
    s_cbranch_scc1 L_qnl
    v_lshlrev_b32 v5, 4, v1
L_qnl:
    s_mov_b64 exec, s[52:53]
    s_cbranch_execz L_qs0
    buffer_load_dwordx4 v[80:83], v5, s[44:47], s12 offen sc1
L_qs0:
    s_mov_b64 exec, s[54:55]
    s_cbranch_execz L_qs1
    buffer_load_dwordx4 v[84:87], v5, s[44:47], s13 offen sc1
L_qs1:
    s_mov_b64 exec, s[56:57]
    s_cbranch_execz L_qs2
    buffer_load_dwordx4 v[88:91], v5, s[44:47], s14 offen sc1
L_qs2:
    s_mov_b64 exec, s[58:59]
    s_cbranch_execz L_qs3
    buffer_load_dwordx4 v[92:95], v5, s[44:47], s43 offen sc1
L_qs3:
    s_mov_b64 exec, -1
    s_waitcnt vmcnt(0)
L_qchk:
    v_xor_b32 v8, v82, v81
    v_xor_b32 v9, v83, v80
    v_xor_b32 v8, s92, v8
    v_subrev_u32 v128, s93, v9
    v_lshrrev_b32 v9, 3, v128
    v_or_b32 v8, v8, v9
    v_cmp_ne_u32_e64 s[52:53], 0, v8
    v_xor_b32 v8, v86, v85
    v_xor_b32 v9, v87, v84
    v_xor_b32 v8, s92, v8
    v_subrev_u32 v129, s93, v9
    v_lshrrev_b32 v9, 3, v129
    v_or_b32 v8, v8, v9
    v_cmp_ne_u32_e64 s[54:55], 0, v8
    v_xor_b32 v8, v90, v89
    v_xor_b32 v9, v91, v88
    v_xor_b32 v8, s92, v8
    v_subrev_u32 v130, s93, v9
    v_lshrrev_b32 v9, 3, v130
    v_or_b32 v8, v8, v9
    v_cmp_ne_u32_e64 s[56:57], 0, v8
    v_xor_b32 v8, v94, v93
    v_xor_b32 v9, v95, v92
    v_xor_b32 v8, s92, v8
    v_subrev_u32 v131, s93, v9
    v_lshrrev_b32 v9, 3, v131
    v_or_b32 v8, v8, v9
    v_cmp_ne_u32_e64 s[58:59], 0, v8
    s_add_u32 s71, s71, 1
    s_cmp_ge_u32 s71, 262144
    s_cbranch_scc1 L_qdone
    s_or_b64 s[8:9], s[52:53], s[54:55]
    s_or_b64 s[10:11], s[56:57], s[58:59]
    s_or_b64 s[8:9], s[8:9], s[10:11]
    s_cbranch_scc1 L_qpoll
L_qdone:
    v_xor_b32 v128, s0, v128
    v_xor_b32 v129, s0, v129
    v_xor_b32 v130, s0, v130
    v_xor_b32 v131, s0, v131
    v_or3_b32 v128, v128, v129, v130
    v_or_b32 v128, v128, v131
    v_cmp_ne_u32 vcc, 0, v128
    s_cmp_eq_u64 vcc, 0
    s_cbranch_scc1 L_alllocal
    s_mov_b64 exec, 1
    ds_add_u32 v163, v162 offset:0
    s_mov_b64 exec, -1
L_alllocal:
    v_pk_add_f32 v[80:81], v[80:81], v[84:85]
    v_pk_add_f32 v[88:89], v[88:89], v[92:93]
    v_pk_add_f32 v[80:81], v[80:81], v[88:89]
    v_cvt_pk_bf16_f32 v8, v80, v81
    v_lshlrev_b32 v9, 2, v1
    s_lshl_b32 s8, s15, 8
    v_add_u32 v9, s8, v9
    ds_write_b32 v9, v8 offset:33792
    s_mov_b64 exec, 1
    ds_add_u32 v163, v162 offset:4
    s_mov_b64 exec, -1
    v_and_b32 v10, 3, v2
    v_lshlrev_b32 v7, 8, v10
    v_lshl_add_u32 v7, v3, 4, v7
    v_lshlrev_b32 v12, 5, v10
    s_lshl_b32 s11, s15, 3
    v_add_u32 v13, s11, v12
    v_lshlrev_b32 v14, 4, v1
    s_lshl_b32 s11, s15, 11
    v_add_u32 v14, s11, v14
    s_mov_b32 s71, 0
L_sp1:
    ds_read_b32 v161, v163 offset:4
    s_add_u32 s71, s71, 1
    s_cmp_ge_u32 s71, 1048576
    s_cbranch_scc1 L_spx1
    s_waitcnt lgkmcnt(0)
    v_readfirstlane_b32 s70, v161
    s_cmp_ge_u32 s70, 4
    s_cbranch_scc1 L_spx1
    s_sleep 1
    s_branch L_sp1
L_spx1:
    ds_read_b128 v[80:83], v7 offset:33792
    ds_read_b128 v[84:87], v7 offset:33856
    ds_read_b128 v[88:91], v7 offset:33920
    ds_read_b128 v[92:95], v7 offset:33984
    s_mov_b32 s8, 0x3db504f3
    s_mov_b32 s9, 0x3db504f3
    s_mov_b32 s10, 0x3fb8aa3b
    s_waitcnt lgkmcnt(0)
    s_waitcnt vmcnt(12)
    ds_read_b128 v[16:19], v136 offset:0
    ds_read_b128 v[20:23], v137 offset:0
    ds_read_b128 v[24:27], v138 offset:0
    ds_read_b128 v[28:31], v139 offset:0
    s_waitcnt vmcnt(8)
    ds_read_b128 v[32:35], v136 offset:4096
    ds_read_b128 v[36:39], v137 offset:4096
    ds_read_b128 v[40:43], v138 offset:4096
    ds_read_b128 v[44:47], v139 offset:4096
    s_waitcnt vmcnt(4)
    ds_read_b128 v[48:51], v136 offset:8192
    ds_read_b128 v[52:55], v137 offset:8192
    ds_read_b128 v[56:59], v138 offset:8192
    ds_read_b128 v[60:63], v139 offset:8192
    s_waitcnt vmcnt(0)
    ds_read_b128 v[64:67], v136 offset:12288
    ds_read_b128 v[68:71], v137 offset:12288
    ds_read_b128 v[72:75], v138 offset:12288
    ds_read_b128 v[76:79], v139 offset:12288
    s_waitcnt lgkmcnt(0)
    v_mfma_f32_16x16x32_bf16 v[96:99], v[16:19], v[80:83], 0
    v_mfma_f32_16x16x32_bf16 v[96:99], v[20:23], v[84:87], v[96:99]
    v_mfma_f32_16x16x32_bf16 v[96:99], v[24:27], v[88:91], v[96:99]
    v_mfma_f32_16x16x32_bf16 v[96:99], v[28:31], v[92:95], v[96:99]
    v_mfma_f32_16x16x32_bf16 v[100:103], v[32:35], v[80:83], 0
    v_mfma_f32_16x16x32_bf16 v[100:103], v[36:39], v[84:87], v[100:103]
    v_mfma_f32_16x16x32_bf16 v[100:103], v[40:43], v[88:91], v[100:103]
    v_mfma_f32_16x16x32_bf16 v[100:103], v[44:47], v[92:95], v[100:103]
    v_mfma_f32_16x16x32_bf16 v[104:107], v[48:51], v[80:83], 0
    v_mfma_f32_16x16x32_bf16 v[104:107], v[52:55], v[84:87], v[104:107]
    v_mfma_f32_16x16x32_bf16 v[104:107], v[56:59], v[88:91], v[104:107]
    v_mfma_f32_16x16x32_bf16 v[104:107], v[60:63], v[92:95], v[104:107]
    v_mfma_f32_16x16x32_bf16 v[108:111], v[64:67], v[80:83], 0
    v_mfma_f32_16x16x32_bf16 v[108:111], v[68:71], v[84:87], v[108:111]
    v_mfma_f32_16x16x32_bf16 v[108:111], v[72:75], v[88:91], v[108:111]
    v_mfma_f32_16x16x32_bf16 v[108:111], v[76:79], v[92:95], v[108:111]
    v_cvt_pk_bf16_f32 v120, v96, v97
    v_cvt_pk_bf16_f32 v121, v98, v99
    v_cvt_pk_bf16_f32 v122, v100, v101
    v_cvt_pk_bf16_f32 v123, v102, v103
    v_cvt_pk_bf16_f32 v124, v104, v105
    v_cvt_pk_bf16_f32 v125, v106, v107
    s_nop 1
    v_cvt_pk_bf16_f32 v126, v108, v109
    v_cvt_pk_bf16_f32 v127, v110, v111
    v_lshlrev_b32 v96, 16, v120
    v_and_b32 v97, s42, v120
    v_lshlrev_b32 v98, 16, v121
    v_and_b32 v99, s42, v121
    v_lshlrev_b32 v100, 16, v122
    v_and_b32 v101, s42, v122
    v_lshlrev_b32 v102, 16, v123
    v_and_b32 v103, s42, v123
    v_lshlrev_b32 v104, 16, v124
    v_and_b32 v105, s42, v124
    v_lshlrev_b32 v106, 16, v125
    v_and_b32 v107, s42, v125
    v_lshlrev_b32 v108, 16, v126
    v_and_b32 v109, s42, v126
    v_lshlrev_b32 v110, 16, v127
    v_and_b32 v111, s42, v127
    v_pk_mul_f32 v[96:97], v[96:97], s[8:9]
    v_pk_mul_f32 v[98:99], v[98:99], s[8:9]
    v_pk_mul_f32 v[100:101], v[100:101], s[8:9]
    v_pk_mul_f32 v[102:103], v[102:103], s[8:9]
    v_pk_mul_f32 v[104:105], v[104:105], s[8:9]
    v_pk_mul_f32 v[106:107], v[106:107], s[8:9]
    v_pk_mul_f32 v[108:109], v[108:109], s[8:9]
    v_pk_mul_f32 v[110:111], v[110:111], s[8:9]
    v_cvt_pk_bf16_f32 v120, v96, v97
    v_cvt_pk_bf16_f32 v121, v98, v99
    v_cvt_pk_bf16_f32 v122, v100, v101
    v_cvt_pk_bf16_f32 v123, v102, v103
    v_cvt_pk_bf16_f32 v124, v104, v105
    v_cvt_pk_bf16_f32 v125, v106, v107
    v_cvt_pk_bf16_f32 v126, v108, v109
    v_cvt_pk_bf16_f32 v127, v110, v111
    v_lshlrev_b32 v96, 16, v120
    v_and_b32 v97, s42, v120
    v_lshlrev_b32 v98, 16, v121
    v_and_b32 v99, s42, v121
    v_lshlrev_b32 v100, 16, v122
    v_and_b32 v101, s42, v122
    v_lshlrev_b32 v102, 16, v123
    v_and_b32 v103, s42, v123
    v_lshlrev_b32 v104, 16, v124
    v_and_b32 v105, s42, v124
    v_lshlrev_b32 v106, 16, v125
    v_and_b32 v107, s42, v125
    v_lshlrev_b32 v108, 16, v126
    v_and_b32 v109, s42, v126
    v_lshlrev_b32 v110, 16, v127
    v_and_b32 v111, s42, v127
    v_max3_f32 v8, v96, v97, v98
    v_max3_f32 v9, v99, v100, v101
    v_max3_f32 v10, v102, v103, v104
    v_max3_f32 v11, v105, v106, v107
    v_max3_f32 v8, v8, v108, v109
    v_max3_f32 v9, v9, v110, v111
    v_max3_f32 v8, v8, v9, v10
    v_max_f32 v8, v8, v11
    v_mov_b32 v9, v8
    s_nop 1
    v_permlane32_swap_b32 v8, v9
    v_max_f32 v8, v8, v9
    v_mov_b32 v9, v8
    s_nop 1
    v_permlane16_swap_b32 v8, v9
    v_max_f32 v8, v8, v9
    v_mul_f32 v10, s10, v8
    v_fma_f32 v96, v96, s10, -v10
    v_fma_f32 v97, v97, s10, -v10
    v_fma_f32 v98, v98, s10, -v10
    v_fma_f32 v99, v99, s10, -v10
    v_fma_f32 v100, v100, s10, -v10
    v_fma_f32 v101, v101, s10, -v10
    v_fma_f32 v102, v102, s10, -v10
    v_fma_f32 v103, v103, s10, -v10
    v_fma_f32 v104, v104, s10, -v10
    v_fma_f32 v105, v105, s10, -v10
    v_fma_f32 v106, v106, s10, -v10
    v_fma_f32 v107, v107, s10, -v10
    v_fma_f32 v108, v108, s10, -v10
    v_fma_f32 v109, v109, s10, -v10
    v_fma_f32 v110, v110, s10, -v10
    v_fma_f32 v111, v111, s10, -v10
    v_exp_f32 v96, v96
    v_exp_f32 v97, v97
    v_exp_f32 v98, v98
    v_exp_f32 v99, v99
    v_exp_f32 v100, v100
    v_exp_f32 v101, v101
    v_exp_f32 v102, v102
    v_exp_f32 v103, v103
    v_exp_f32 v104, v104
    v_exp_f32 v105, v105
    v_exp_f32 v106, v106
    v_exp_f32 v107, v107
    v_exp_f32 v108, v108
    v_exp_f32 v109, v109
    v_exp_f32 v110, v110
    v_exp_f32 v111, v111
    v_cvt_pk_bf16_f32 v112, v96, v97
    v_cvt_pk_bf16_f32 v113, v98, v99
    v_cvt_pk_bf16_f32 v114, v100, v101
    v_cvt_pk_bf16_f32 v115, v102, v103
    v_cvt_pk_bf16_f32 v116, v104, v105
    v_cvt_pk_bf16_f32 v117, v106, v107
    v_cvt_pk_bf16_f32 v118, v108, v109
    v_cvt_pk_bf16_f32 v119, v110, v111
    ds_write_b128 v14, v[112:115] offset:34816
    ds_write_b128 v14, v[116:119] offset:35840
    s_mov_b64 exec, 1
    ds_add_u32 v164, v162 offset:32
    s_mov_b64 exec, -1
    v_pk_add_f32 v[96:97], v[96:97], v[104:105]
    v_pk_add_f32 v[98:99], v[98:99], v[106:107]
    v_pk_add_f32 v[100:101], v[100:101], v[108:109]
    v_pk_add_f32 v[102:103], v[102:103], v[110:111]
    v_pk_add_f32 v[96:97], v[96:97], v[100:101]
    v_pk_add_f32 v[98:99], v[98:99], v[102:103]
    v_pk_add_f32 v[96:97], v[96:97], v[98:99]
    v_add_f32 v9, v96, v97
    v_mov_b32 v11, v9
    s_nop 1
    v_permlane32_swap_b32 v9, v11
    v_add_f32 v9, v9, v11
    v_mov_b32 v11, v9
    s_nop 1
    v_permlane16_swap_b32 v9, v11
    v_add_f32 v9, v9, v11
    s_mov_b64 exec, 15
    ds_write_b64 v13, v[8:9] offset:43008
    s_mov_b64 exec, -1
    s_mov_b64 exec, 1
    ds_add_u32 v163, v162 offset:12
    s_mov_b64 exec, -1
    s_mov_b32 s71, 0
L_sp2:
    ds_read_b32 v161, v163 offset:12
    s_add_u32 s71, s71, 1
    s_cmp_ge_u32 s71, 1048576
    s_cbranch_scc1 L_spx2
    s_waitcnt lgkmcnt(0)
    v_readfirstlane_b32 s70, v161
    s_cmp_ge_u32 s70, 4
    s_cbranch_scc1 L_spx2
    s_sleep 1
    s_branch L_sp2
L_spx2:
    s_lshl_b32 s11, s15, 5
    v_mov_b32 v12, s11
    ds_read_b128 v[16:19], v12 offset:43008
    ds_read_b128 v[20:23], v12 offset:43024
    ds_read_b32 v27, v163 offset:0
    s_waitcnt lgkmcnt(0)
    v_readfirstlane_b32 s1, v27
    v_max3_f32 v24, v16, v18, v20
    v_max_f32 v24, v24, v22
    v_sub_f32 v152, v16, v24
    v_mul_f32 v152, s10, v152
    v_exp_f32 v152, v152
    v_sub_f32 v153, v18, v24
    v_mul_f32 v153, s10, v153
    v_exp_f32 v153, v153
    v_sub_f32 v154, v20, v24
    v_mul_f32 v154, s10, v154
    v_exp_f32 v154, v154
    v_sub_f32 v155, v22, v24
    v_mul_f32 v155, s10, v155
    v_exp_f32 v155, v155
    v_mul_f32 v25, v152, v17
    v_fmac_f32 v25, v153, v19
    v_fmac_f32 v25, v154, v21
    v_fmac_f32 v25, v155, v23
    v_rcp_f32 v26, v25
    v_log_f32 v25, v25
    v_mul_f32 v152, v152, v26
    v_mul_f32 v153, v153, v26
    v_mul_f32 v154, v154, v26
    v_mul_f32 v155, v155, v26
    v_fma_f32 v25, v24, s10, v25
    v_min_u32 v158, -2, v25
    v_lshlrev_b32 v156, 3, v1
    s_mul_i32 s11, s15, 576
    v_add_u32 v156, s11, v156
    v_lshlrev_b32 v157, 2, v2
    v_lshl_add_u32 v157, v3, 11, v157
    s_cmp_ge_u32 s26, 4
    s_cbranch_scc1 L_tdone
    s_mov_b32 s71, 0
L_tpoll:
    buffer_load_dwordx2 v[128:129], v6, s[44:47], s68 offen sc1
    s_waitcnt vmcnt(0)
    v_xor_b32 v16, s92, v128
    v_xor_b32 v17, s93, v129
    v_or_b32 v16, v16, v17
    v_cmp_ne_u32 vcc, 0, v16
    s_add_u32 s71, s71, 1
    s_cmp_ge_u32 s71, 262144
    s_cbranch_scc1 L_tdone
    s_cmp_lg_u64 vcc, 0
    s_cbranch_scc1 L_tpoll
L_tdone:
    s_lshl_b32 s11, s4, 15
    s_lshr_b32 s13, s7, 2
    s_lshl_b32 s13, s13, 10
    s_add_u32 s11, s11, s13
    s_lshl_b32 s13, s6, 8
    s_add_u32 s11, s11, s13
    s_and_b32 s13, s7, 3
    s_lshl_b32 s13, s13, 6
    s_add_u32 s11, s11, s13
    s_add_u32 s11, s11, 0x40000
    s_lshl_b32 s13, s15, 13
    s_add_u32 s68, s11, s13
    s_lshl_b32 s62, s4, 9
    s_lshl_b32 s13, s6, 5
    s_add_u32 s62, s62, s13
    s_and_b32 s13, s7, 3
    s_lshl_b32 s13, s13, 3
    s_add_u32 s62, s62, s13
    s_lshr_b32 s13, s7, 2
    s_lshl_b32 s13, s13, 2
    s_add_u32 s62, s62, s13
    s_add_u32 s62, s62, 0x2000
    s_lshl_b32 s13, s15, 7
    s_add_u32 s62, s62, s13
    s_call_b64 s[100:101], L_fsetup
    s_mov_b64 exec, 1
    s_cmp_lg_u32 s1, 0
    s_cbranch_scc1 L_lstg
    buffer_store_dword v158, v160, s[44:47], s62 offen
    s_branch L_lsd
L_lstg:
    buffer_store_dword v158, v160, s[44:47], s62 offen sc1
L_lsd:
    s_mov_b64 exec, -1
    s_waitcnt lgkmcnt(0)
    s_barrier
    ds_read_b64 v[16:17], v156 offset:0
    ds_read_b64 v[18:19], v156 offset:2304
    ds_read_b64 v[20:21], v156 offset:4608
    ds_read_b64 v[22:23], v156 offset:6912
    s_waitcnt lgkmcnt(0)
    v_pk_mul_f32 v[16:17], v[16:17], v[152:153] op_sel:[0,0] op_sel_hi:[1,0]
    v_pk_mul_f32 v[20:21], v[20:21], v[154:155] op_sel:[0,0] op_sel_hi:[1,0]
    v_pk_fma_f32 v[16:17], v[18:19], v[152:153], v[16:17] op_sel:[0,1,0] op_sel_hi:[1,1,1]
    v_pk_fma_f32 v[20:21], v[22:23], v[154:155], v[20:21] op_sel:[0,1,0] op_sel_hi:[1,1,1]
    v_pk_add_f32 v[16:17], v[16:17], v[20:21]
    v_cvt_pk_bf16_f32 v16, v16, v17
    v_min_u32 v16, -2, v16
    s_cmp_lg_u32 s1, 0
    s_cbranch_scc1 L_ostg
    buffer_store_dword v16, v157, s[44:47], s68 offen
    s_branch L_B5
L_ostg:
    buffer_store_dword v16, v157, s[44:47], s68 offen sc1
    s_branch L_B5
L_fsetup:
    s_sub_u32 s63, s3, 4
    s_lshr_b32 s13, s5, 4
    s_lshl_b32 s14, s4, 1
    s_add_u32 s13, s13, s14
    s_lshl_b32 s13, s13, 11
    s_and_b32 s14, s5, 15
    s_lshl_b32 s14, s14, 7
    s_add_u32 s13, s13, s14
    v_lshlrev_b32 v148, 15, v3
    v_lshl_add_u32 v148, v2, 3, v148
    v_lshlrev_b32 v149, 3, v1
    s_add_u32 s69, s13, 0x10000
    s_mov_b32 s56, s16
    s_and_b32 s57, s17, 0xffff
    s_mov_b32 s58, 0x1000
    s_mov_b32 s59, 0x20000
    v_and_b32 v8, 1, v3
    v_lshlrev_b32 v8, 1, v8
    v_lshrrev_b32 v9, 1, v3
    v_or_b32 v8, v8, v9
    v_lshl_add_u32 v8, v2, 2, v8
    s_lshl_b32 s8, s63, 6
    v_add_u32 v8, s8, v8
    v_lshlrev_b32 v147, 1, v8
    s_and_b32 s8, s26, 3
    s_lshl_b32 s43, s8, 10
    v_lshlrev_b32 v146, 11, v3
    v_lshl_add_u32 v146, v2, 4, v146
    s_lshl_b32 s11, s63, 3
    v_lshrrev_b32 v150, 5, v1
    v_lshlrev_b32 v150, 2, v150
    v_add_u32 v150, s11, v150
    s_cmp_ge_u32 s26, 4
    s_cbranch_scc1 L_fs1
    buffer_load_ushort v144, v147, s[56:59], s43 offen
L_fs1:
    s_setpc_b64 s[100:101]
L_Q2:
    s_setprio 1
    s_waitcnt vmcnt(18)
    s_mov_b32 s8, 0x3f803f80
    v_mov_b32 v10, 0
    v_mov_b32 v11, 0
    v_mov_b32 v12, 0
    v_mov_b32 v13, 0
    v_dot2_f32_bf16 v10, v16, s8, v10
    v_dot2_f32_bf16 v11, v16, v16, v11
    v_dot2_f32_bf16 v12, v17, s8, v12
    v_dot2_f32_bf16 v13, v17, v17, v13
    v_dot2_f32_bf16 v10, v18, s8, v10
    v_dot2_f32_bf16 v11, v18, v18, v11
    v_dot2_f32_bf16 v12, v19, s8, v12
    v_dot2_f32_bf16 v13, v19, v19, v13
    v_dot2_f32_bf16 v10, v20, s8, v10
    v_dot2_f32_bf16 v11, v20, v20, v11
    v_dot2_f32_bf16 v12, v21, s8, v12
    v_dot2_f32_bf16 v13, v21, v21, v13
    v_dot2_f32_bf16 v10, v22, s8, v10
    v_dot2_f32_bf16 v11, v22, v22, v11
    v_dot2_f32_bf16 v12, v23, s8, v12
    v_dot2_f32_bf16 v13, v23, v23, v13
    v_dot2_f32_bf16 v10, v24, s8, v10
    v_dot2_f32_bf16 v11, v24, v24, v11
    v_dot2_f32_bf16 v12, v25, s8, v12
    v_dot2_f32_bf16 v13, v25, v25, v13
    v_dot2_f32_bf16 v10, v26, s8, v10
    v_dot2_f32_bf16 v11, v26, v26, v11
    v_dot2_f32_bf16 v12, v27, s8, v12
    v_dot2_f32_bf16 v13, v27, v27, v13
    v_dot2_f32_bf16 v10, v28, s8, v10
    v_dot2_f32_bf16 v11, v28, v28, v11
    v_dot2_f32_bf16 v12, v29, s8, v12
    v_dot2_f32_bf16 v13, v29, v29, v13
    v_dot2_f32_bf16 v10, v30, s8, v10
    v_dot2_f32_bf16 v11, v30, v30, v11
    v_dot2_f32_bf16 v12, v31, s8, v12
    v_dot2_f32_bf16 v13, v31, v31, v13
    s_nop 2
    v_pk_add_f32 v[10:11], v[10:11], v[12:13]
    s_nop 1
    v_add_f32_dpp v10, v10, v10 row_ror:4 row_mask:0xf bank_mask:0xf
    v_add_f32_dpp v11, v11, v11 row_ror:4 row_mask:0xf bank_mask:0xf
    s_nop 0
    v_add_f32_dpp v10, v10, v10 row_ror:8 row_mask:0xf bank_mask:0xf
    v_add_f32_dpp v11, v11, v11 row_ror:8 row_mask:0xf bank_mask:0xf
    v_mov_b32 v12, v10
    v_mov_b32 v13, v11
    s_nop 0
    v_permlane32_swap_b32 v10, v12
    v_permlane32_swap_b32 v11, v13
    v_pk_add_f32 v[10:11], v[10:11], v[12:13]
    v_mov_b32 v12, v10
    v_mov_b32 v13, v11
    s_nop 0
    v_permlane16_swap_b32 v10, v12
    v_permlane16_swap_b32 v11, v13
    v_pk_add_f32 v[10:11], v[10:11], v[12:13]
    s_mov_b32 s8, 0x3b000000
    s_mov_b32 s9, 0x3b000000
    s_mov_b32 s10, 0x3727c5ac
    v_pk_mul_f32 v[10:11], v[10:11], s[8:9]
    v_fma_f32 v11, -v10, v10, v11
    v_max_f32 v11, 0, v11
    v_cvt_pk_bf16_f32 v12, v10, v11
    v_and_b32 v11, s42, v12
    v_lshlrev_b32 v10, 16, v12
    v_add_f32 v11, s10, v11
    v_cvt_pk_bf16_f32 v12, v11, v11
    v_and_b32 v11, s42, v12
    v_sqrt_f32 v11, v11
    s_nop 0
    v_cvt_pk_bf16_f32 v12, v11, v11
    v_and_b32 v11, s42, v12
    v_rcp_f32 v11, v11
    s_waitcnt vmcnt(16)
    v_lshlrev_b32 v16, 16, v32
    v_and_b32 v17, s42, v32
    v_lshlrev_b32 v18, 16, v33
    v_and_b32 v19, s42, v33
    v_lshlrev_b32 v20, 16, v34
    v_and_b32 v21, s42, v34
    v_lshlrev_b32 v22, 16, v35
    v_and_b32 v23, s42, v35
    v_pk_add_f32 v[16:17], v[16:17], v[10:11] op_sel:[0,0] op_sel_hi:[1,0] neg_lo:[0,1] neg_hi:[0,1]
    v_pk_add_f32 v[18:19], v[18:19], v[10:11] op_sel:[0,0] op_sel_hi:[1,0] neg_lo:[0,1] neg_hi:[0,1]
    v_pk_add_f32 v[20:21], v[20:21], v[10:11] op_sel:[0,0] op_sel_hi:[1,0] neg_lo:[0,1] neg_hi:[0,1]
    v_pk_add_f32 v[22:23], v[22:23], v[10:11] op_sel:[0,0] op_sel_hi:[1,0] neg_lo:[0,1] neg_hi:[0,1]
    v_cvt_pk_bf16_f32 v32, v16, v17
    v_cvt_pk_bf16_f32 v33, v18, v19
    v_cvt_pk_bf16_f32 v34, v20, v21
    v_cvt_pk_bf16_f32 v35, v22, v23
    v_lshlrev_b32 v16, 16, v32
    v_and_b32 v17, s42, v32
    v_lshlrev_b32 v18, 16, v33
    v_and_b32 v19, s42, v33
    v_lshlrev_b32 v20, 16, v34
    v_and_b32 v21, s42, v34
    v_lshlrev_b32 v22, 16, v35
    v_and_b32 v23, s42, v35
    v_pk_mul_f32 v[16:17], v[16:17], v[10:11] op_sel:[0,1] op_sel_hi:[1,1]
    v_pk_mul_f32 v[18:19], v[18:19], v[10:11] op_sel:[0,1] op_sel_hi:[1,1]
    v_pk_mul_f32 v[20:21], v[20:21], v[10:11] op_sel:[0,1] op_sel_hi:[1,1]
    v_pk_mul_f32 v[22:23], v[22:23], v[10:11] op_sel:[0,1] op_sel_hi:[1,1]
    v_cvt_pk_bf16_f32 v32, v16, v17
    v_cvt_pk_bf16_f32 v33, v18, v19
    v_cvt_pk_bf16_f32 v34, v20, v21
    v_cvt_pk_bf16_f32 v35, v22, v23
    v_lshlrev_b32 v8, 8, v4
    v_lshl_add_u32 v8, v3, 4, v8
    v_lshl_add_u32 v9, v7, 6, v8
    ds_write_b128 v9, v[32:35] offset:32768
    ds_read_b128 v[36:39], v8 offset:32768
    ds_read_b128 v[40:43], v8 offset:32832
    ds_read_b128 v[44:47], v8 offset:32896
    ds_read_b128 v[48:51], v8 offset:32960
    v_lshrrev_b32 v9, 2, v2
    v_lshl_add_u32 v9, v3, 2, v9
    v_bfe_u32 v14, v9, 1, 2
    v_lshlrev_b32 v9, 7, v9
    v_lshl_add_u32 v9, v4, 3, v9
    v_xor_b32 v15, 0, v14
    v_lshl_add_u32 v10, v15, 5, v9
    v_xor_b32 v15, 1, v14
    v_lshl_add_u32 v11, v15, 5, v9
    v_xor_b32 v15, 2, v14
    v_lshl_add_u32 v12, v15, 5, v9
    v_xor_b32 v15, 3, v14
    v_lshl_add_u32 v13, v15, 5, v9
    s_waitcnt lgkmcnt(0)
    s_mul_i32 s92, s94, 0x85ebca6b
    s_add_u32 s92, s92, 0x7f4a7c15
    s_mul_i32 s93, s94, 0x9e3779b1
    s_add_u32 s93, s93, 0x1b873593
    s_waitcnt vmcnt(12)
    ds_read_b64_tr_b16 v[52:53], v10 offset:0
    ds_read_b64_tr_b16 v[54:55], v10 offset:2048
    ds_read_b64_tr_b16 v[56:57], v11 offset:0
    ds_read_b64_tr_b16 v[58:59], v11 offset:2048
    ds_read_b64_tr_b16 v[60:61], v12 offset:0
    ds_read_b64_tr_b16 v[62:63], v12 offset:2048
    ds_read_b64_tr_b16 v[64:65], v13 offset:0
    ds_read_b64_tr_b16 v[66:67], v13 offset:2048
    s_waitcnt vmcnt(8)
    ds_read_b64_tr_b16 v[68:69], v10 offset:4096
    ds_read_b64_tr_b16 v[70:71], v10 offset:6144
    ds_read_b64_tr_b16 v[72:73], v11 offset:4096
    ds_read_b64_tr_b16 v[74:75], v11 offset:6144
    ds_read_b64_tr_b16 v[76:77], v12 offset:4096
    ds_read_b64_tr_b16 v[78:79], v12 offset:6144
    ds_read_b64_tr_b16 v[80:81], v13 offset:4096
    ds_read_b64_tr_b16 v[82:83], v13 offset:6144
    s_waitcnt vmcnt(4)
    ds_read_b64_tr_b16 v[84:85], v10 offset:8192
    ds_read_b64_tr_b16 v[86:87], v10 offset:10240
    ds_read_b64_tr_b16 v[88:89], v11 offset:8192
    ds_read_b64_tr_b16 v[90:91], v11 offset:10240
    ds_read_b64_tr_b16 v[92:93], v12 offset:8192
    ds_read_b64_tr_b16 v[94:95], v12 offset:10240
    ds_read_b64_tr_b16 v[96:97], v13 offset:8192
    ds_read_b64_tr_b16 v[98:99], v13 offset:10240
    s_waitcnt vmcnt(0)
    ds_read_b64_tr_b16 v[100:101], v10 offset:12288
    ds_read_b64_tr_b16 v[102:103], v10 offset:14336
    ds_read_b64_tr_b16 v[104:105], v11 offset:12288
    ds_read_b64_tr_b16 v[106:107], v11 offset:14336
    ds_read_b64_tr_b16 v[108:109], v12 offset:12288
    ds_read_b64_tr_b16 v[110:111], v12 offset:14336
    ds_read_b64_tr_b16 v[112:113], v13 offset:12288
    ds_read_b64_tr_b16 v[114:115], v13 offset:14336
    v_cmp_eq_u32_e64 s[52:53], 1, v7
    v_cmp_eq_u32_e64 s[54:55], 2, v7
    v_cmp_eq_u32_e64 s[56:57], 3, v7
    v_lshlrev_b32 v8, 14, v4
    v_lshl_add_u32 v8, v7, 7, v8
    v_lshl_add_u32 v8, v3, 5, v8
    s_lshl_b32 s8, s4, 16
    s_lshl_b32 s9, s6, 12
    s_add_u32 s8, s8, s9
    s_lshl_b32 s9, s7, 9
    s_add_u32 s8, s8, s9
    s_add_u32 s8, s8, 0x90000
    s_add_u32 s93, s93, s0
    s_waitcnt lgkmcnt(0)
    v_mfma_f32_16x16x32_bf16 v[116:119], v[52:55], v[36:39], 0
    v_mfma_f32_16x16x32_bf16 v[120:123], v[56:59], v[36:39], 0
    v_mfma_f32_16x16x32_bf16 v[124:127], v[60:63], v[36:39], 0
    v_mfma_f32_16x16x32_bf16 v[128:131], v[64:67], v[36:39], 0
    v_mfma_f32_16x16x32_bf16 v[116:119], v[68:71], v[40:43], v[116:119]
    v_mfma_f32_16x16x32_bf16 v[120:123], v[72:75], v[40:43], v[120:123]
    v_mfma_f32_16x16x32_bf16 v[124:127], v[76:79], v[40:43], v[124:127]
    v_mfma_f32_16x16x32_bf16 v[128:131], v[80:83], v[40:43], v[128:131]
    v_mfma_f32_16x16x32_bf16 v[116:119], v[84:87], v[44:47], v[116:119]
    v_mfma_f32_16x16x32_bf16 v[120:123], v[88:91], v[44:47], v[120:123]
    v_mfma_f32_16x16x32_bf16 v[124:127], v[92:95], v[44:47], v[124:127]
    v_mfma_f32_16x16x32_bf16 v[128:131], v[96:99], v[44:47], v[128:131]
    v_mfma_f32_16x16x32_bf16 v[116:119], v[100:103], v[48:51], v[116:119]
    v_mfma_f32_16x16x32_bf16 v[120:123], v[104:107], v[48:51], v[120:123]
    v_mfma_f32_16x16x32_bf16 v[124:127], v[108:111], v[48:51], v[124:127]
    v_mfma_f32_16x16x32_bf16 v[128:131], v[112:115], v[48:51], v[128:131]
    s_nop 5
    v_cndmask_b32_e64 v116, v116, v120, s[52:53]
    v_cndmask_b32_e64 v117, v117, v121, s[52:53]
    v_cndmask_b32_e64 v118, v118, v122, s[52:53]
    v_cndmask_b32_e64 v119, v119, v123, s[52:53]
    v_cndmask_b32_e64 v116, v116, v124, s[54:55]
    v_cndmask_b32_e64 v117, v117, v125, s[54:55]
    v_cndmask_b32_e64 v118, v118, v126, s[54:55]
    v_cndmask_b32_e64 v119, v119, v127, s[54:55]
    v_cndmask_b32_e64 v116, v116, v128, s[56:57]
    v_cndmask_b32_e64 v117, v117, v129, s[56:57]
    v_cndmask_b32_e64 v118, v118, v130, s[56:57]
    v_cndmask_b32_e64 v119, v119, v131, s[56:57]
    s_mov_b32 s71, 0
L_sp3:
    ds_read_b32 v161, v163 offset:52
    s_add_u32 s71, s71, 1
    s_cmp_ge_u32 s71, 1048576
    s_cbranch_scc1 L_spx3
    s_waitcnt lgkmcnt(0)
    v_readfirstlane_b32 s70, v161
    s_cmp_ge_u32 s70, 1
    s_cbranch_scc1 L_spx3
    s_sleep 1
    s_branch L_sp3
L_spx3:
    v_mov_b32 v136, v116
    v_mov_b32 v137, v117
    v_xor_b32 v138, s92, v117
    v_xor_b32 v139, s93, v116
    v_mov_b32 v140, v118
    v_mov_b32 v141, v119
    v_xor_b32 v142, s92, v119
    v_xor_b32 v143, s93, v118
    s_add_u32 s9, s8, 0x80000
    s_setprio 3
    buffer_store_dwordx4 v[136:139], v8, s[44:47], s9 offen
    buffer_store_dwordx4 v[140:143], v8, s[44:47], s9 offen offset:16
    buffer_store_dwordx4 v[136:139], v8, s[44:47], s8 offen sc1
    buffer_store_dwordx4 v[140:143], v8, s[44:47], s8 offen offset:16 sc1
    s_setprio 0
    s_branch L_C
L_C123:
    s_cmp_lg_u32 s3, 1
    s_cbranch_scc1 L_C23
    v_lshlrev_b32 v4, 2, v2
    ds_write_b32 v4, v160 offset:43456
    s_mov_b32 s48, s28
    s_and_b32 s49, s29, 0xffff
    s_mov_b32 s50, 0xe00
    s_mov_b32 s51, 0x20000
    s_mov_b32 s52, s30
    s_and_b32 s53, s31, 0xffff
    s_mov_b32 s54, 0xe00
    s_mov_b32 s55, 0x20000
    s_mov_b32 s56, s32
    s_and_b32 s57, s33, 0xffff
    s_mov_b32 s58, 0xe00
    s_mov_b32 s59, 0x20000
    v_lshlrev_b32 v6, 4, v1
    s_waitcnt lgkmcnt(0)
    s_mov_b32 m0, 43520
    s_nop 0
    buffer_load_dwordx4 v6, s[48:51], 0 offen offset:0 lds
    buffer_load_dwordx4 v6, s[48:51], 0 offen offset:1024 lds
    buffer_load_dwordx4 v6, s[48:51], 0 offen offset:2048 lds
    buffer_load_dwordx4 v6, s[48:51], 0 offen offset:3072 lds
    s_mov_b32 m0, 47616
    s_nop 0
    buffer_load_dwordx4 v6, s[52:55], 0 offen offset:0 lds
    buffer_load_dwordx4 v6, s[52:55], 0 offen offset:1024 lds
    buffer_load_dwordx4 v6, s[52:55], 0 offen offset:2048 lds
    buffer_load_dwordx4 v6, s[52:55], 0 offen offset:3072 lds
    s_mov_b32 m0, 51712
    s_nop 0
    buffer_load_dwordx4 v6, s[56:59], 0 offen offset:0 lds
    buffer_load_dwordx4 v6, s[56:59], 0 offen offset:1024 lds
    buffer_load_dwordx4 v6, s[56:59], 0 offen offset:2048 lds
    buffer_load_dwordx4 v6, s[56:59], 0 offen offset:3072 lds
    s_barrier
    s_setprio 0
    s_waitcnt vmcnt(0)
    s_mov_b64 exec, 1
    ds_add_u32 v163, v162 offset:8
    s_mov_b64 exec, -1
    s_branch L_C
L_C23:
    s_cmp_eq_u32 s3, 2
    s_cbranch_scc1 L_C2
    s_barrier
    s_waitcnt vmcnt(0)
    s_branch L_C
L_C2:
    s_lshl_b32 s11, s4, 5
    s_add_u32 s11, s11, s5
    v_mov_b32 v8, -1
    v_mov_b32 v9, -1
    v_mov_b32 v10, -1
    v_mov_b32 v11, -1
    v_lshlrev_b32 v4, 4, v1
    s_lshl_b32 s11, s4, 15
    s_lshr_b32 s13, s7, 2
    s_lshl_b32 s13, s13, 10
    s_add_u32 s11, s11, s13
    s_lshl_b32 s13, s6, 8
    s_add_u32 s11, s11, s13
    s_and_b32 s13, s7, 3
    s_lshl_b32 s13, s13, 6
    s_add_u32 s11, s11, s13
    s_add_u32 s11, s11, 0x40000
    s_lshl_b32 s62, s4, 9
    s_lshl_b32 s13, s6, 5
    s_add_u32 s62, s62, s13
    s_and_b32 s13, s7, 3
    s_lshl_b32 s13, s13, 3
    s_add_u32 s62, s62, s13
    s_lshr_b32 s13, s7, 2
    s_lshl_b32 s13, s13, 2
    s_add_u32 s62, s62, s13
    s_add_u32 s62, s62, 0x2000
    s_mov_b32 s12, s11
    v_lshrrev_b32 v12, 2, v1
    v_lshlrev_b32 v12, 11, v12
    v_and_b32 v13, 3, v1
    v_lshl_add_u32 v12, v13, 4, v12
    v_lshlrev_b32 v13, 7, v1
    buffer_store_dwordx4 v[8:11], v12, s[44:47], s12 offen sc1
    v_lshlrev_b32 v5, 15, v3
    v_lshl_add_u32 v5, v2, 3, v5
    s_lshr_b32 s13, s5, 4
    s_lshl_b32 s14, s4, 1
    s_add_u32 s13, s13, s14
    s_lshl_b32 s13, s13, 11
    s_and_b32 s14, s5, 15
    s_lshl_b32 s14, s14, 7
    s_add_u32 s13, s13, s14
    s_add_u32 s13, s13, 0x10000
    buffer_store_dwordx2 v[8:9], v5, s[44:47], s13 offen sc1
    s_mov_b64 exec, 15
    buffer_store_dword v8, v13, s[44:47], s62 offen sc1
    s_mul_i32 s14, s2, 48
    s_add_u32 s14, s14, 0x4000
    s_mov_b64 exec, 7
    buffer_store_dwordx4 v[8:11], v4, s[44:47], s14 offen sc1
    s_mov_b64 exec, -1
    s_barrier
    s_waitcnt vmcnt(0) lgkmcnt(0)
    s_mul_i32 s92, s94, 0x85ebca6b
    s_add_u32 s92, s92, 0x7f4a7c15
    s_mul_i32 s93, s94, 0x9e3779b1
    s_add_u32 s93, s93, 0x1b873593
    s_mov_b64 exec, 1
    ds_add_u32 v163, v162 offset:52
    s_mov_b64 exec, -1
    s_setprio 3
    buffer_load_dwordx4 v[152:155], v12, s[44:47], s12 offen sc1
    v_mov_b32 v8, s92
    v_mov_b32 v9, s93
    s_lshl_b32 s9, s2, 3
    s_add_u32 s9, s9, 0x1000
    s_mov_b64 exec, 1
    buffer_store_dwordx2 v[8:9], v160, s[44:47], s9 offen sc1
    s_mov_b64 exec, -1
    s_setprio 0
    s_mov_b64 exec, 1
    ds_add_u32 v163, v162 offset:8
    s_mov_b64 exec, -1
L_C:
    s_mov_b32 s71, 0
L_sp4:
    ds_read_b32 v161, v163 offset:8
    s_add_u32 s71, s71, 1
    s_cmp_ge_u32 s71, 1048576
    s_cbranch_scc1 L_spx4
    s_waitcnt lgkmcnt(0)
    v_readfirstlane_b32 s70, v161
    s_cmp_ge_u32 s70, 2
    s_cbranch_scc1 L_spx4
    s_sleep 1
    s_branch L_sp4
L_spx4:
    v_lshlrev_b32 v4, 2, v1
    ds_read_b32 v17, v4 offset:43520
    ds_read_b32 v19, v4 offset:43776
    ds_read_b32 v21, v4 offset:44032
    ds_read_b32 v23, v4 offset:44288
    ds_read_b32 v25, v4 offset:44544
    ds_read_b32 v27, v4 offset:44800
    ds_read_b32 v29, v4 offset:45056
    ds_read_b32 v31, v4 offset:45312
    ds_read_b32 v33, v4 offset:45568
    ds_read_b32 v35, v4 offset:45824
    ds_read_b32 v37, v4 offset:46080
    ds_read_b32 v39, v4 offset:46336
    ds_read_b32 v41, v4 offset:46592
    ds_read_b32 v43, v4 offset:46848
    ds_read_b32 v45, v4 offset:47616
    ds_read_b32 v47, v4 offset:47872
    ds_read_b32 v49, v4 offset:48128
    ds_read_b32 v51, v4 offset:48384
    ds_read_b32 v53, v4 offset:48640
    ds_read_b32 v55, v4 offset:48896
    ds_read_b32 v57, v4 offset:49152
    ds_read_b32 v59, v4 offset:49408
    ds_read_b32 v61, v4 offset:49664
    ds_read_b32 v63, v4 offset:49920
    ds_read_b32 v65, v4 offset:50176
    ds_read_b32 v67, v4 offset:50432
    ds_read_b32 v69, v4 offset:50688
    ds_read_b32 v71, v4 offset:50944
    ds_read_b32 v73, v4 offset:51712
    ds_read_b32 v75, v4 offset:51968
    ds_read_b32 v77, v4 offset:52224
    ds_read_b32 v79, v4 offset:52480
    ds_read_b32 v81, v4 offset:52736
    ds_read_b32 v83, v4 offset:52992
    ds_read_b32 v85, v4 offset:53248
    ds_read_b32 v87, v4 offset:53504
    ds_read_b32 v89, v4 offset:53760
    ds_read_b32 v91, v4 offset:54016
    ds_read_b32 v93, v4 offset:54272
    ds_read_b32 v95, v4 offset:54528
    ds_read_b32 v97, v4 offset:54784
    ds_read_b32 v99, v4 offset:55040
    s_mov_b32 s8, 0xbeeff558
    s_mov_b32 s9, 0xbeeff558
    s_mov_b32 s10, 0xc0088e99
    s_mov_b32 s11, 0xc0088e99
    s_waitcnt lgkmcnt(0)
    v_lshlrev_b32 v16, 16, v17
    v_and_b32 v17, s42, v17
    v_lshlrev_b32 v18, 16, v19
    v_and_b32 v19, s42, v19
    v_lshlrev_b32 v20, 16, v21
    v_and_b32 v21, s42, v21
    v_lshlrev_b32 v22, 16, v23
    v_and_b32 v23, s42, v23
    v_lshlrev_b32 v24, 16, v25
    v_and_b32 v25, s42, v25
    v_lshlrev_b32 v26, 16, v27
    v_and_b32 v27, s42, v27
    v_lshlrev_b32 v28, 16, v29
    v_and_b32 v29, s42, v29
    v_lshlrev_b32 v30, 16, v31
    v_and_b32 v31, s42, v31
    v_lshlrev_b32 v32, 16, v33
    v_and_b32 v33, s42, v33
    v_lshlrev_b32 v34, 16, v35
    v_and_b32 v35, s42, v35
    v_lshlrev_b32 v36, 16, v37
    v_and_b32 v37, s42, v37
    v_lshlrev_b32 v38, 16, v39
    v_and_b32 v39, s42, v39
    v_lshlrev_b32 v40, 16, v41
    v_and_b32 v41, s42, v41
    v_lshlrev_b32 v42, 16, v43
    v_and_b32 v43, s42, v43
    v_lshlrev_b32 v44, 16, v45
    v_and_b32 v45, s42, v45
    v_lshlrev_b32 v46, 16, v47
    v_and_b32 v47, s42, v47
    v_lshlrev_b32 v48, 16, v49
    v_and_b32 v49, s42, v49
    v_lshlrev_b32 v50, 16, v51
    v_and_b32 v51, s42, v51
    v_lshlrev_b32 v52, 16, v53
    v_and_b32 v53, s42, v53
    v_lshlrev_b32 v54, 16, v55
    v_and_b32 v55, s42, v55
    v_lshlrev_b32 v56, 16, v57
    v_and_b32 v57, s42, v57
    v_lshlrev_b32 v58, 16, v59
    v_and_b32 v59, s42, v59
    v_lshlrev_b32 v60, 16, v61
    v_and_b32 v61, s42, v61
    v_lshlrev_b32 v62, 16, v63
    v_and_b32 v63, s42, v63
    v_lshlrev_b32 v64, 16, v65
    v_and_b32 v65, s42, v65
    v_lshlrev_b32 v66, 16, v67
    v_and_b32 v67, s42, v67
    v_lshlrev_b32 v68, 16, v69
    v_and_b32 v69, s42, v69
    v_lshlrev_b32 v70, 16, v71
    v_and_b32 v71, s42, v71
    v_lshlrev_b32 v72, 16, v73
    v_and_b32 v73, s42, v73
    v_lshlrev_b32 v74, 16, v75
    v_and_b32 v75, s42, v75
    v_lshlrev_b32 v76, 16, v77
    v_and_b32 v77, s42, v77
    v_lshlrev_b32 v78, 16, v79
    v_and_b32 v79, s42, v79
    v_lshlrev_b32 v80, 16, v81
    v_and_b32 v81, s42, v81
    v_lshlrev_b32 v82, 16, v83
    v_and_b32 v83, s42, v83
    v_lshlrev_b32 v84, 16, v85
    v_and_b32 v85, s42, v85
    v_lshlrev_b32 v86, 16, v87
    v_and_b32 v87, s42, v87
    v_lshlrev_b32 v88, 16, v89
    v_and_b32 v89, s42, v89
    v_lshlrev_b32 v90, 16, v91
    v_and_b32 v91, s42, v91
    v_lshlrev_b32 v92, 16, v93
    v_and_b32 v93, s42, v93
    v_lshlrev_b32 v94, 16, v95
    v_and_b32 v95, s42, v95
    v_lshlrev_b32 v96, 16, v97
    v_and_b32 v97, s42, v97
    v_lshlrev_b32 v98, 16, v99
    v_and_b32 v99, s42, v99
    v_pk_mul_f32 v[16:17], v[16:17], s[8:9]
    v_pk_mul_f32 v[18:19], v[18:19], s[8:9]
    v_pk_mul_f32 v[20:21], v[20:21], s[8:9]
    v_pk_mul_f32 v[22:23], v[22:23], s[8:9]
    v_pk_mul_f32 v[24:25], v[24:25], s[8:9]
    v_pk_mul_f32 v[26:27], v[26:27], s[8:9]
    v_pk_mul_f32 v[28:29], v[28:29], s[8:9]
    v_pk_mul_f32 v[30:31], v[30:31], s[8:9]
    v_pk_mul_f32 v[32:33], v[32:33], s[8:9]
    v_pk_mul_f32 v[34:35], v[34:35], s[8:9]
    v_pk_mul_f32 v[36:37], v[36:37], s[8:9]
    v_pk_mul_f32 v[38:39], v[38:39], s[8:9]
    v_pk_mul_f32 v[40:41], v[40:41], s[8:9]
    v_pk_mul_f32 v[42:43], v[42:43], s[8:9]
    v_pk_mul_f32 v[44:45], v[44:45], s[8:9]
    v_pk_mul_f32 v[46:47], v[46:47], s[8:9]
    v_pk_mul_f32 v[48:49], v[48:49], s[8:9]
    v_pk_mul_f32 v[50:51], v[50:51], s[8:9]
    v_pk_mul_f32 v[52:53], v[52:53], s[8:9]
    v_pk_mul_f32 v[54:55], v[54:55], s[8:9]
    v_pk_mul_f32 v[56:57], v[56:57], s[8:9]
    v_pk_mul_f32 v[58:59], v[58:59], s[8:9]
    v_pk_mul_f32 v[60:61], v[60:61], s[8:9]
    v_pk_mul_f32 v[62:63], v[62:63], s[8:9]
    v_pk_mul_f32 v[64:65], v[64:65], s[8:9]
    v_pk_mul_f32 v[66:67], v[66:67], s[8:9]
    v_pk_mul_f32 v[68:69], v[68:69], s[8:9]
    v_pk_mul_f32 v[70:71], v[70:71], s[8:9]
    v_pk_mul_f32 v[72:73], v[72:73], s[10:11]
    v_pk_mul_f32 v[74:75], v[74:75], s[10:11]
    v_pk_mul_f32 v[76:77], v[76:77], s[10:11]
    v_pk_mul_f32 v[78:79], v[78:79], s[10:11]
    v_pk_mul_f32 v[80:81], v[80:81], s[10:11]
    v_pk_mul_f32 v[82:83], v[82:83], s[10:11]
    v_pk_mul_f32 v[84:85], v[84:85], s[10:11]
    v_pk_mul_f32 v[86:87], v[86:87], s[10:11]
    v_pk_mul_f32 v[88:89], v[88:89], s[10:11]
    v_pk_mul_f32 v[90:91], v[90:91], s[10:11]
    v_pk_mul_f32 v[92:93], v[92:93], s[10:11]
    v_pk_mul_f32 v[94:95], v[94:95], s[10:11]
    v_pk_mul_f32 v[96:97], v[96:97], s[10:11]
    v_pk_mul_f32 v[98:99], v[98:99], s[10:11]
    s_mov_b32 s62, 0x409d30fc
    s_mov_b32 s63, 0x409d30fc
    s_mul_i32 s95, s2, 24
    s_mul_i32 s96, s3, 6
    s_add_u32 s95, s95, s96
    s_add_u32 s96, s95, 6
    v_lshlrev_b32 v145, 16, v145
L_tab1:
    s_cmp_ge_u32 s95, 3072
    s_cselect_b32 s97, 29696, 0
    s_add_u32 s97, s97, s95
    s_add_u32 s97, s97, 13824
    s_lshl_b32 s97, s97, 16
    v_mov_b32 v100, s97
    s_call_b64 s[100:101], L_eval
    v_alignbit_b32 v136, v137, v136, 16
    v_alignbit_b32 v137, v138, v137, 16
    v_alignbit_b32 v138, v102, v138, 16
    s_add_u32 s95, s95, 1
    s_cmp_lt_u32 s95, s96
    s_cbranch_scc1 L_tab1
    s_lshl_b32 s97, s96, 1
    s_add_u32 s97, s97, 0x3ff4
    s_mov_b32 exec_lo, 0
    s_mov_b32 exec_hi, 0x80000000
    s_setprio 3
    buffer_store_dwordx3 v[136:138], v160, s[44:47], s97 offen sc1
    s_mov_b64 exec, -1
    s_cmp_ge_u32 s26, 4
    s_cbranch_scc1 L_fin
L_dry_ret:
    s_mov_b64 s[98:99], -1
    s_mov_b64 exec, -1
    s_mov_b32 s48, s36
    s_and_b32 s49, s37, 0xffff
    s_mov_b32 s50, 0x1000
    s_mov_b32 s51, 0x20000
    v_lshlrev_b32 v4, 4, v1
    s_mul_i32 s12, s3, 3072
    s_add_u32 m0, s12, 16384
    s_add_u32 s12, s12, 0x4000
    s_barrier
    s_barrier
    s_mov_b32 s71, 0
    s_mul_i32 s13, s3, 3072
    v_add_u32 v5, s13, v4
L_tfetch:
    buffer_load_dwordx4 v4, s[44:47], s12 offen offset:0 sc1 lds
    buffer_load_dwordx4 v4, s[44:47], s12 offen offset:1024 sc1 lds
    buffer_load_dwordx4 v4, s[44:47], s12 offen offset:2048 sc1 lds
    s_waitcnt vmcnt(0)
    ds_read_b128 v[108:111], v5 offset:16384
    ds_read_b128 v[112:115], v5 offset:17408
    ds_read_b128 v[116:119], v5 offset:18432
    s_waitcnt lgkmcnt(0)
    v_max3_u32 v108, v108, v109, v110
    v_max3_u32 v111, v111, v112, v113
    v_max3_u32 v114, v114, v115, v116
    v_max3_u32 v117, v117, v118, v119
    v_max3_u32 v108, v108, v111, v114
    v_max_u32 v108, v108, v117
    v_cmp_eq_u32 vcc, -1, v108
    s_add_u32 s71, s71, 1
    s_cmp_ge_u32 s71, 4
    s_cbranch_scc1 L_tfd
    s_cmp_lg_u64 vcc, 0
    s_cbranch_scc1 L_tfetch
L_tfd:
    s_barrier
    s_barrier
    ds_read_b32 v4, v163 offset:48
    s_waitcnt lgkmcnt(0)
    v_readfirstlane_b32 s96, v4
    s_mov_b32 s95, s3
    s_lshl_b32 s43, s26, 10
L_fb:
    s_cmp_ge_u32 s95, s96
    s_cbranch_scc1 L_fin
    s_lshl_b32 s8, s95, 3
    v_mov_b32 v4, s8
    ds_read_b64 v[6:7], v4 offset:11264
    s_waitcnt lgkmcnt(0)
    v_and_b32 v100, s42, v6
    v_and_b32 v6, 0xffff, v6
    s_call_b64 s[100:101], L_eval
    v_and_b32 v8, s42, v102
    v_add_f32 v8, v8, v7
    v_cvt_pk_bf16_f32 v8, v8, v8
    s_mov_b32 exec_lo, 0
    s_mov_b32 exec_hi, 0x80000000
    buffer_store_short v8, v6, s[48:51], s43 offen
    s_mov_b64 exec, -1
    s_add_u32 s95, s95, 4
    s_branch L_fb
L_eval:
    v_pk_fma_f32 v[108:109], v[16:17], v[100:101], v[44:45] op_sel:[0,0,0] op_sel_hi:[1,0,1]
    v_pk_fma_f32 v[112:113], v[18:19], v[100:101], v[46:47] op_sel:[0,0,0] op_sel_hi:[1,0,1]
    v_pk_fma_f32 v[116:117], v[20:21], v[100:101], v[48:49] op_sel:[0,0,0] op_sel_hi:[1,0,1]
    v_pk_fma_f32 v[120:121], v[22:23], v[100:101], v[50:51] op_sel:[0,0,0] op_sel_hi:[1,0,1]
    v_pk_fma_f32 v[124:125], v[24:25], v[100:101], v[52:53] op_sel:[0,0,0] op_sel_hi:[1,0,1]
    v_pk_fma_f32 v[128:129], v[26:27], v[100:101], v[54:55] op_sel:[0,0,0] op_sel_hi:[1,0,1]
    v_pk_fma_f32 v[132:133], v[28:29], v[100:101], v[56:57] op_sel:[0,0,0] op_sel_hi:[1,0,1]
    v_pk_fma_f32 v[110:111], v[108:109], v[108:109], s[62:63]
    v_pk_fma_f32 v[114:115], v[112:113], v[112:113], s[62:63]
    v_pk_fma_f32 v[118:119], v[116:117], v[116:117], s[62:63]
    v_pk_fma_f32 v[122:123], v[120:121], v[120:121], s[62:63]
    v_pk_fma_f32 v[126:127], v[124:125], v[124:125], s[62:63]
    v_pk_fma_f32 v[130:131], v[128:129], v[128:129], s[62:63]
    v_pk_fma_f32 v[134:135], v[132:133], v[132:133], s[62:63]
    v_pk_mul_f32 v[110:111], v[110:111], v[108:109]
    v_pk_mul_f32 v[114:115], v[114:115], v[112:113]
    v_pk_mul_f32 v[118:119], v[118:119], v[116:117]
    v_pk_mul_f32 v[122:123], v[122:123], v[120:121]
    v_pk_mul_f32 v[126:127], v[126:127], v[124:125]
    v_pk_mul_f32 v[130:131], v[130:131], v[128:129]
    v_pk_mul_f32 v[134:135], v[134:135], v[132:133]
    v_exp_f32 v110, v110
    v_exp_f32 v111, v111
    v_pk_mul_f32 v[108:109], v[108:109], v[72:73]
    v_exp_f32 v114, v114
    v_exp_f32 v115, v115
    v_pk_mul_f32 v[112:113], v[112:113], v[74:75]
    v_exp_f32 v118, v118
    v_exp_f32 v119, v119
    v_pk_mul_f32 v[116:117], v[116:117], v[76:77]
    v_exp_f32 v122, v122
    v_exp_f32 v123, v123
    v_pk_mul_f32 v[120:121], v[120:121], v[78:79]
    v_exp_f32 v126, v126
    v_exp_f32 v127, v127
    v_pk_mul_f32 v[124:125], v[124:125], v[80:81]
    v_exp_f32 v130, v130
    v_exp_f32 v131, v131
    v_pk_mul_f32 v[128:129], v[128:129], v[82:83]
    v_exp_f32 v134, v134
    v_exp_f32 v135, v135
    v_pk_mul_f32 v[132:133], v[132:133], v[84:85]
    v_pk_add_f32 v[110:111], v[110:111], 1.0 op_sel_hi:[1,0]
    v_pk_add_f32 v[114:115], v[114:115], 1.0 op_sel_hi:[1,0]
    v_pk_add_f32 v[118:119], v[118:119], 1.0 op_sel_hi:[1,0]
    v_pk_add_f32 v[122:123], v[122:123], 1.0 op_sel_hi:[1,0]
    v_pk_add_f32 v[126:127], v[126:127], 1.0 op_sel_hi:[1,0]
    v_pk_add_f32 v[130:131], v[130:131], 1.0 op_sel_hi:[1,0]
    v_pk_add_f32 v[134:135], v[134:135], 1.0 op_sel_hi:[1,0]
    v_rcp_f32 v110, v110
    v_rcp_f32 v111, v111
    v_rcp_f32 v114, v114
    v_rcp_f32 v115, v115
    v_rcp_f32 v118, v118
    v_rcp_f32 v119, v119
    v_rcp_f32 v122, v122
    v_rcp_f32 v123, v123
    v_rcp_f32 v126, v126
    v_rcp_f32 v127, v127
    v_rcp_f32 v130, v130
    v_rcp_f32 v131, v131
    v_rcp_f32 v134, v134
    v_rcp_f32 v135, v135
    v_pk_mul_f32 v[102:103], v[108:109], v[110:111]
    v_pk_mul_f32 v[104:105], v[112:113], v[114:115]
    v_pk_fma_f32 v[102:103], v[116:117], v[118:119], v[102:103]
    v_pk_fma_f32 v[104:105], v[120:121], v[122:123], v[104:105]
    v_pk_fma_f32 v[102:103], v[124:125], v[126:127], v[102:103]
    v_pk_fma_f32 v[104:105], v[128:129], v[130:131], v[104:105]
    v_pk_fma_f32 v[102:103], v[132:133], v[134:135], v[102:103]
    v_pk_fma_f32 v[108:109], v[30:31], v[100:101], v[58:59] op_sel:[0,0,0] op_sel_hi:[1,0,1]
    v_pk_fma_f32 v[112:113], v[32:33], v[100:101], v[60:61] op_sel:[0,0,0] op_sel_hi:[1,0,1]
    v_pk_fma_f32 v[116:117], v[34:35], v[100:101], v[62:63] op_sel:[0,0,0] op_sel_hi:[1,0,1]
    v_pk_fma_f32 v[120:121], v[36:37], v[100:101], v[64:65] op_sel:[0,0,0] op_sel_hi:[1,0,1]
    v_pk_fma_f32 v[124:125], v[38:39], v[100:101], v[66:67] op_sel:[0,0,0] op_sel_hi:[1,0,1]
    v_pk_fma_f32 v[128:129], v[40:41], v[100:101], v[68:69] op_sel:[0,0,0] op_sel_hi:[1,0,1]
    v_pk_fma_f32 v[132:133], v[42:43], v[100:101], v[70:71] op_sel:[0,0,0] op_sel_hi:[1,0,1]
    v_pk_fma_f32 v[110:111], v[108:109], v[108:109], s[62:63]
    v_pk_fma_f32 v[114:115], v[112:113], v[112:113], s[62:63]
    v_pk_fma_f32 v[118:119], v[116:117], v[116:117], s[62:63]
    v_pk_fma_f32 v[122:123], v[120:121], v[120:121], s[62:63]
    v_pk_fma_f32 v[126:127], v[124:125], v[124:125], s[62:63]
    v_pk_fma_f32 v[130:131], v[128:129], v[128:129], s[62:63]
    v_pk_fma_f32 v[134:135], v[132:133], v[132:133], s[62:63]
    v_pk_mul_f32 v[110:111], v[110:111], v[108:109]
    v_pk_mul_f32 v[114:115], v[114:115], v[112:113]
    v_pk_mul_f32 v[118:119], v[118:119], v[116:117]
    v_pk_mul_f32 v[122:123], v[122:123], v[120:121]
    v_pk_mul_f32 v[126:127], v[126:127], v[124:125]
    v_pk_mul_f32 v[130:131], v[130:131], v[128:129]
    v_pk_mul_f32 v[134:135], v[134:135], v[132:133]
    v_exp_f32 v110, v110
    v_exp_f32 v111, v111
    v_pk_mul_f32 v[108:109], v[108:109], v[86:87]
    v_exp_f32 v114, v114
    v_exp_f32 v115, v115
    v_pk_mul_f32 v[112:113], v[112:113], v[88:89]
    v_exp_f32 v118, v118
    v_exp_f32 v119, v119
    v_pk_mul_f32 v[116:117], v[116:117], v[90:91]
    v_exp_f32 v122, v122
    v_exp_f32 v123, v123
    v_pk_mul_f32 v[120:121], v[120:121], v[92:93]
    v_exp_f32 v126, v126
    v_exp_f32 v127, v127
    v_pk_mul_f32 v[124:125], v[124:125], v[94:95]
    v_exp_f32 v130, v130
    v_exp_f32 v131, v131
    v_pk_mul_f32 v[128:129], v[128:129], v[96:97]
    v_exp_f32 v134, v134
    v_exp_f32 v135, v135
    v_pk_mul_f32 v[132:133], v[132:133], v[98:99]
    v_pk_add_f32 v[110:111], v[110:111], 1.0 op_sel_hi:[1,0]
    v_pk_add_f32 v[114:115], v[114:115], 1.0 op_sel_hi:[1,0]
    v_pk_add_f32 v[118:119], v[118:119], 1.0 op_sel_hi:[1,0]
    v_pk_add_f32 v[122:123], v[122:123], 1.0 op_sel_hi:[1,0]
    v_pk_add_f32 v[126:127], v[126:127], 1.0 op_sel_hi:[1,0]
    v_pk_add_f32 v[130:131], v[130:131], 1.0 op_sel_hi:[1,0]
    v_pk_add_f32 v[134:135], v[134:135], 1.0 op_sel_hi:[1,0]
    v_rcp_f32 v110, v110
    v_rcp_f32 v111, v111
    v_rcp_f32 v114, v114
    v_rcp_f32 v115, v115
    v_rcp_f32 v118, v118
    v_rcp_f32 v119, v119
    v_rcp_f32 v122, v122
    v_rcp_f32 v123, v123
    v_rcp_f32 v126, v126
    v_rcp_f32 v127, v127
    v_rcp_f32 v130, v130
    v_rcp_f32 v131, v131
    v_rcp_f32 v134, v134
    v_rcp_f32 v135, v135
    v_pk_fma_f32 v[102:103], v[108:109], v[110:111], v[102:103]
    v_pk_fma_f32 v[104:105], v[112:113], v[114:115], v[104:105]
    v_pk_fma_f32 v[102:103], v[116:117], v[118:119], v[102:103]
    v_pk_fma_f32 v[104:105], v[120:121], v[122:123], v[104:105]
    v_pk_fma_f32 v[102:103], v[124:125], v[126:127], v[102:103]
    v_pk_fma_f32 v[104:105], v[128:129], v[130:131], v[104:105]
    v_pk_fma_f32 v[102:103], v[132:133], v[134:135], v[102:103]
    v_pk_add_f32 v[102:103], v[102:103], v[104:105]
    v_add_f32 v102, v102, v103
    s_nop 1
    v_add_f32_dpp v102, v102, v102 row_shr:1 row_mask:0xf bank_mask:0xf bound_ctrl:0
    s_nop 1
    v_add_f32_dpp v102, v102, v102 row_shr:2 row_mask:0xf bank_mask:0xf bound_ctrl:0
    s_nop 1
    v_add_f32_dpp v102, v102, v102 row_shr:4 row_mask:0xf bank_mask:0xf bound_ctrl:0
    s_nop 1
    v_add_f32_dpp v102, v102, v102 row_shr:8 row_mask:0xf bank_mask:0xf bound_ctrl:0
    s_nop 1
    v_add_f32_dpp v102, v102, v102 row_bcast:15 row_mask:0xa bank_mask:0xf
    s_nop 1
    v_add_f32_dpp v102, v102, v102 row_bcast:31 row_mask:0xc bank_mask:0xf
    v_cvt_pk_bf16_f32 v102, v102, v102
    v_and_b32 v102, s42, v102
    v_add_f32 v102, v102, v145
    v_cvt_pk_bf16_f32 v102, v102, v102
    s_setpc_b64 s[100:101]
L_V:
    s_setprio 2
    s_barrier
    s_call_b64 s[100:101], L_fsetup
    s_mov_b32 s48, s20
    s_and_b32 s49, s21, 0xffff
    s_mov_b32 s50, 0x4000000
    s_mov_b32 s51, 0x20000
    s_mov_b32 s52, s24
    s_and_b32 s53, s25, 0xffff
    s_mov_b32 s54, 0x400000
    s_mov_b32 s55, 0x20000
    v_lshlrev_b32 v5, 4, v2
    v_lshl_add_u32 v5, v3, 10, v5
    v_lshlrev_b32 v14, 4, v1
    s_lshl_b32 s11, s15, 11
    v_add_u32 v14, s11, v14
    v_mul_u32_u24 v15, 576, v2
    v_lshl_add_u32 v15, v3, 4, v15
    s_mul_i32 s11, s15, 2304
    v_add_u32 v15, s11, v15
    v_and_b32 v7, 1, v3
    v_lshlrev_b32 v8, 6, v7
    v_bfe_u32 v9, v1, 2, 2
    v_lshl_add_u32 v8, v9, 3, v8
    v_lshrrev_b32 v9, 5, v1
    v_add_u32 v8, v8, v9
    v_lshlrev_b32 v8, 10, v8
    v_and_b32 v9, 3, v1
    v_lshlrev_b32 v7, 1, v7
    v_xor_b32 v9, v9, v7
    v_lshl_add_u32 v8, v9, 4, v8
    s_lshl_b32 s8, s4, 19
    s_lshr_b32 s9, s5, 4
    s_lshl_b32 s9, s9, 18
    s_add_u32 s8, s8, s9
    s_and_b32 s9, s5, 15
    s_lshl_b32 s9, s9, 6
    s_add_u32 s8, s8, s9
    s_lshr_b32 s9, s15, 1
    s_lshl_b32 s9, s9, 17
    s_add_u32 s8, s8, s9
    s_and_b32 s9, s15, 1
    s_lshl_b32 s9, s9, 12
    s_add_u32 s8, s8, s9
    s_lshl_b32 s14, s15, 12
    s_add_u32 s14, s14, 16384
    s_lshr_b32 s9, s5, 4
    s_lshl_b32 s9, s9, 1
    s_lshr_b32 s10, s15, 1
    s_add_u32 s9, s9, s10
    s_lshl_b32 s10, s4, 15
    s_add_u32 s10, s10, 0x40000
    s_lshl_b32 s11, s9, 13
    s_add_u32 s10, s10, s11
    s_and_b32 s11, s15, 1
    s_lshl_b32 s11, s11, 12
    s_add_u32 s60, s10, s11
    s_lshl_b32 s10, s4, 9
    s_lshl_b32 s11, s9, 7
    s_add_u32 s58, s10, s11
    s_add_u32 s58, s58, 0x2000
    v_lshrrev_b32 v6, 2, v2
    v_and_b32 v7, 3, v2
    v_lshlrev_b32 v155, 3, v2
    v_lshlrev_b32 v152, 6, v2
    v_lshl_add_u32 v152, v3, 4, v152
    v_lshrrev_b32 v7, 2, v2
    v_lshl_add_u32 v7, v3, 2, v7
    v_lshlrev_b32 v7, 6, v7
    v_and_b32 v9, 3, v2
    v_lshl_add_u32 v7, v9, 3, v7
    v_and_b32 v9, 1, v3
    v_lshl_add_u32 v153, v9, 5, v7
    v_xor_b32 v9, 1, v9
    v_lshl_add_u32 v154, v9, 5, v7
    v_add_u32 v153, s14, v153
    v_add_u32 v154, s14, v154
    v_lshlrev_b32 v156, 7, v6
    v_lshl_add_u32 v156, v3, 4, v156
    s_lshl_b32 s10, s15, 9
    v_add_u32 v156, s10, v156
    s_mov_b32 s96, 0x11111111
    s_mov_b32 s97, 0x11111111
    s_mov_b32 s12, 0x05040100
    s_mov_b32 s13, 0x07060302
    s_mov_b32 s56, 0x000f000f
    s_mov_b32 s57, 0x000f000f
    s_mov_b32 s71, 0
L_sp5:
    ds_read_b32 v161, v164 offset:16
    s_add_u32 s71, s71, 1
    s_cmp_ge_u32 s71, 1048576
    s_cbranch_scc1 L_spx5
    s_waitcnt lgkmcnt(0)
    v_readfirstlane_b32 s70, v161
    s_cmp_ge_u32 s70, 1
    s_cbranch_scc1 L_spx5
    s_sleep 2
    s_branch L_sp5
L_spx5:
    buffer_load_dwordx4 v[16:19], v5, s[48:51], s64 offen offset:0 nt
    buffer_load_dwordx4 v[20:23], v5, s[48:51], s64 offen offset:256 nt
    buffer_load_dwordx4 v[24:27], v5, s[48:51], s64 offen offset:512 nt
    buffer_load_dwordx4 v[28:31], v5, s[48:51], s64 offen offset:768 nt
    buffer_load_dwordx4 v[32:35], v5, s[48:51], s65 offen offset:0 nt
    buffer_load_dwordx4 v[36:39], v5, s[48:51], s65 offen offset:256 nt
    s_waitcnt vmcnt(5)
    buffer_load_dwordx4 v[40:43], v5, s[48:51], s65 offen offset:512 nt
    s_waitcnt vmcnt(5)
    buffer_load_dwordx4 v[44:47], v5, s[48:51], s65 offen offset:768 nt
    s_waitcnt vmcnt(5)
    buffer_load_dwordx4 v[48:51], v5, s[48:51], s66 offen offset:0 nt
    s_waitcnt vmcnt(5)
    buffer_load_dwordx4 v[52:55], v5, s[48:51], s66 offen offset:256 nt
    s_waitcnt vmcnt(5)
    buffer_load_dwordx4 v[56:59], v5, s[48:51], s66 offen offset:512 nt
    s_waitcnt vmcnt(5)
    buffer_load_dwordx4 v[60:63], v5, s[48:51], s66 offen offset:768 nt
    s_waitcnt vmcnt(5)
    buffer_load_dwordx4 v[64:67], v5, s[48:51], s67 offen offset:0 nt
    s_waitcnt vmcnt(5)
    buffer_load_dwordx4 v[68:71], v5, s[48:51], s67 offen offset:256 nt
    s_waitcnt vmcnt(5)
    buffer_load_dwordx4 v[72:75], v5, s[48:51], s67 offen offset:512 nt
    s_waitcnt vmcnt(5)
    buffer_load_dwordx4 v[76:79], v5, s[48:51], s67 offen offset:768 nt
    s_mov_b64 exec, 1
    ds_add_u32 v163, v162 offset:56
    s_mov_b64 exec, -1
    s_mov_b32 s71, 0
L_sp6:
    ds_read_b32 v161, v163 offset:56
    s_add_u32 s71, s71, 1
    s_cmp_ge_u32 s71, 1048576
    s_cbranch_scc1 L_spx6
    s_waitcnt lgkmcnt(0)
    v_readfirstlane_b32 s70, v161
    s_cmp_ge_u32 s70, 4
    s_cbranch_scc1 L_spx6
    s_sleep 1
    s_branch L_sp6
L_spx6:
    s_add_u32 s9, s8, 0x0
    s_add_u32 m0, s14, 0
    s_nop 0
    buffer_load_dwordx4 v8, s[52:55], s9 offen nt lds
    s_add_u32 s9, s8, 0x8000
    s_add_u32 m0, s14, 1024
    s_nop 0
    buffer_load_dwordx4 v8, s[52:55], s9 offen nt lds
    s_add_u32 s9, s8, 0x800
    s_add_u32 m0, s14, 2048
    s_nop 0
    buffer_load_dwordx4 v8, s[52:55], s9 offen nt lds
    s_add_u32 s9, s8, 0x8800
    s_add_u32 m0, s14, 3072
    s_nop 0
    buffer_load_dwordx4 v8, s[52:55], s9 offen nt lds
    s_mov_b32 s71, 0
L_sp7:
    ds_read_b32 v161, v164 offset:32
    s_add_u32 s71, s71, 1
    s_cmp_ge_u32 s71, 1048576
    s_cbranch_scc1 L_spx7
    s_waitcnt lgkmcnt(0)
    v_readfirstlane_b32 s70, v161
    s_cmp_ge_u32 s70, 1
    s_cbranch_scc1 L_spx7
    s_sleep 1
    s_branch L_sp7
L_spx7:
    ds_read_b128 v[6:9], v14 offset:34816
    ds_read_b128 v[10:13], v14 offset:35840
    s_waitcnt lgkmcnt(0)
    s_waitcnt vmcnt(18)
    v_perm_b32 v112, v20, v16, s12
    v_perm_b32 v116, v20, v16, s13
    v_perm_b32 v120, v21, v17, s12
    v_perm_b32 v124, v21, v17, s13
    v_perm_b32 v128, v22, v18, s12
    v_perm_b32 v132, v22, v18, s13
    v_perm_b32 v136, v23, v19, s12
    v_perm_b32 v140, v23, v19, s13
    s_waitcnt vmcnt(16)
    v_perm_b32 v113, v28, v24, s12
    v_perm_b32 v117, v28, v24, s13
    v_perm_b32 v121, v29, v25, s12
    v_perm_b32 v125, v29, v25, s13
    v_perm_b32 v129, v30, v26, s12
    v_perm_b32 v133, v30, v26, s13
    v_perm_b32 v137, v31, v27, s12
    v_perm_b32 v141, v31, v27, s13
    s_waitcnt vmcnt(14)
    v_perm_b32 v114, v36, v32, s12
    v_perm_b32 v118, v36, v32, s13
    v_perm_b32 v122, v37, v33, s12
    v_perm_b32 v126, v37, v33, s13
    v_perm_b32 v130, v38, v34, s12
    v_perm_b32 v134, v38, v34, s13
    v_perm_b32 v138, v39, v35, s12
    v_perm_b32 v142, v39, v35, s13
    s_waitcnt vmcnt(12)
    v_perm_b32 v115, v44, v40, s12
    v_perm_b32 v119, v44, v40, s13
    v_perm_b32 v123, v45, v41, s12
    v_perm_b32 v127, v45, v41, s13
    v_perm_b32 v131, v46, v42, s12
    v_perm_b32 v135, v46, v42, s13
    v_perm_b32 v139, v47, v43, s12
    v_perm_b32 v143, v47, v43, s13
    v_mfma_f32_16x16x32_bf16 v[80:83], v[112:115], v[6:9], 0
    v_mfma_f32_16x16x32_bf16 v[84:87], v[116:119], v[6:9], 0
    v_mfma_f32_16x16x32_bf16 v[88:91], v[120:123], v[6:9], 0
    v_mfma_f32_16x16x32_bf16 v[92:95], v[124:127], v[6:9], 0
    v_mfma_f32_16x16x32_bf16 v[96:99], v[128:131], v[6:9], 0
    v_mfma_f32_16x16x32_bf16 v[100:103], v[132:135], v[6:9], 0
    v_mfma_f32_16x16x32_bf16 v[104:107], v[136:139], v[6:9], 0
    v_mfma_f32_16x16x32_bf16 v[108:111], v[140:143], v[6:9], 0
    s_waitcnt vmcnt(10)
    v_perm_b32 v112, v52, v48, s12
    v_perm_b32 v116, v52, v48, s13
    v_perm_b32 v120, v53, v49, s12
    v_perm_b32 v124, v53, v49, s13
    v_perm_b32 v128, v54, v50, s12
    v_perm_b32 v132, v54, v50, s13
    v_perm_b32 v136, v55, v51, s12
    v_perm_b32 v140, v55, v51, s13
    s_waitcnt vmcnt(8)
    v_perm_b32 v113, v60, v56, s12
    v_perm_b32 v117, v60, v56, s13
    v_perm_b32 v121, v61, v57, s12
    v_perm_b32 v125, v61, v57, s13
    v_perm_b32 v129, v62, v58, s12
    v_perm_b32 v133, v62, v58, s13
    v_perm_b32 v137, v63, v59, s12
    v_perm_b32 v141, v63, v59, s13
    s_waitcnt vmcnt(6)
    v_perm_b32 v114, v68, v64, s12
    v_perm_b32 v118, v68, v64, s13
    v_perm_b32 v122, v69, v65, s12
    v_perm_b32 v126, v69, v65, s13
    v_perm_b32 v130, v70, v66, s12
    v_perm_b32 v134, v70, v66, s13
    v_perm_b32 v138, v71, v67, s12
    v_perm_b32 v142, v71, v67, s13
    s_waitcnt vmcnt(4)
    v_perm_b32 v115, v76, v72, s12
    v_perm_b32 v119, v76, v72, s13
    v_perm_b32 v123, v77, v73, s12
    v_perm_b32 v127, v77, v73, s13
    v_perm_b32 v131, v78, v74, s12
    v_perm_b32 v135, v78, v74, s13
    v_perm_b32 v139, v79, v75, s12
    v_perm_b32 v143, v79, v75, s13
    v_mfma_f32_16x16x32_bf16 v[80:83], v[112:115], v[10:13], v[80:83]
    v_mfma_f32_16x16x32_bf16 v[84:87], v[116:119], v[10:13], v[84:87]
    v_mfma_f32_16x16x32_bf16 v[88:91], v[120:123], v[10:13], v[88:91]
    v_mfma_f32_16x16x32_bf16 v[92:95], v[124:127], v[10:13], v[92:95]
    v_mfma_f32_16x16x32_bf16 v[96:99], v[128:131], v[10:13], v[96:99]
    v_mfma_f32_16x16x32_bf16 v[100:103], v[132:135], v[10:13], v[100:103]
    v_mfma_f32_16x16x32_bf16 v[104:107], v[136:139], v[10:13], v[104:107]
    v_mfma_f32_16x16x32_bf16 v[108:111], v[140:143], v[10:13], v[108:111]
    s_mov_b64 exec, s[56:57]
    ds_write_b128 v15, v[80:83] offset:0
    ds_write_b128 v15, v[84:87] offset:64
    ds_write_b128 v15, v[88:91] offset:128
    ds_write_b128 v15, v[92:95] offset:192
    ds_write_b128 v15, v[96:99] offset:256
    ds_write_b128 v15, v[100:103] offset:320
    ds_write_b128 v15, v[104:107] offset:384
    ds_write_b128 v15, v[108:111] offset:448
    s_mov_b64 exec, -1
    s_waitcnt lgkmcnt(0)
    s_barrier
    buffer_load_dwordx4 v[16:19], v152, s[44:47], s60 offen offset:0 sc1
    buffer_load_dwordx4 v[20:23], v152, s[44:47], s60 offen offset:2048 sc1
    buffer_load_dword v64, v155, s[44:47], s58 offen offset:0 sc1
    buffer_load_dwordx4 v[24:27], v152, s[44:47], s60 offen offset:1024 sc1
    buffer_load_dwordx4 v[28:31], v152, s[44:47], s60 offen offset:3072 sc1
    buffer_load_dword v65, v155, s[44:47], s58 offen offset:4 sc1
    s_waitcnt vmcnt(6)
    ds_read_b64_tr_b16 v[32:33], v153 offset:0
    ds_read_b64_tr_b16 v[34:35], v153 offset:1024
    ds_read_b64_tr_b16 v[36:37], v154 offset:0
    ds_read_b64_tr_b16 v[38:39], v154 offset:1024
    ds_read_b64_tr_b16 v[40:41], v153 offset:2048
    ds_read_b64_tr_b16 v[42:43], v153 offset:3072
    ds_read_b64_tr_b16 v[44:45], v154 offset:2048
    ds_read_b64_tr_b16 v[46:47], v154 offset:3072
    s_mov_b32 s71, 0
L_h1chk:
    s_waitcnt vmcnt(0)
    v_max3_u32 v8, v16, v17, v18
    v_max3_u32 v9, v24, v25, v26
    v_max3_u32 v8, v8, v19, v20
    v_max3_u32 v9, v9, v27, v28
    v_max3_u32 v8, v8, v21, v22
    v_max3_u32 v9, v9, v29, v30
    v_max3_u32 v8, v8, v23, v64
    v_max3_u32 v9, v9, v31, v65
    v_cmp_eq_u32_e64 s[52:53], -1, v8
    v_cmp_eq_u32_e64 s[54:55], -1, v9
    s_or_b64 s[56:57], s[52:53], s[54:55]
    s_cbranch_scc0 L_h1done
    s_add_u32 s71, s71, 1
    s_cmp_ge_u32 s71, 262144
    s_cbranch_scc1 L_h1done
    s_mov_b64 exec, s[52:53]
    s_cbranch_execz L_h1s0
    buffer_load_dwordx4 v[16:19], v152, s[44:47], s60 offen offset:0 sc1
    buffer_load_dwordx4 v[20:23], v152, s[44:47], s60 offen offset:2048 sc1
    buffer_load_dword v64, v155, s[44:47], s58 offen offset:0 sc1
L_h1s0:
    s_mov_b64 exec, s[54:55]
    s_cbranch_execz L_h1s1
    buffer_load_dwordx4 v[24:27], v152, s[44:47], s60 offen offset:1024 sc1
    buffer_load_dwordx4 v[28:31], v152, s[44:47], s60 offen offset:3072 sc1
    buffer_load_dword v65, v155, s[44:47], s58 offen offset:4 sc1
L_h1s1:
    s_mov_b64 exec, -1
    s_branch L_h1chk
L_h1done:
    s_waitcnt lgkmcnt(0)
    v_mfma_f32_16x16x32_bf16 v[48:51], v[32:35], v[16:19], 0
    v_max_f32 v8, v64, v65
    v_mfma_f32_16x16x32_bf16 v[52:55], v[32:35], v[24:27], 0
    s_nop 0
    v_max_f32_dpp v8, v8, v8 quad_perm:[1,0,3,2] row_mask:0xf bank_mask:0xf
    v_mfma_f32_16x16x32_bf16 v[56:59], v[36:39], v[16:19], 0
    s_nop 0
    v_max_f32_dpp v8, v8, v8 quad_perm:[2,3,0,1] row_mask:0xf bank_mask:0xf
    v_mfma_f32_16x16x32_bf16 v[60:63], v[36:39], v[24:27], 0
    v_sub_f32 v64, v64, v8
    v_sub_f32 v65, v65, v8
    v_mfma_f32_16x16x32_bf16 v[48:51], v[40:43], v[20:23], v[48:51]
    v_exp_f32 v64, v64
    v_exp_f32 v65, v65
    v_mfma_f32_16x16x32_bf16 v[52:55], v[40:43], v[28:31], v[52:55]
    v_add_f32 v8, v64, v65
    v_mfma_f32_16x16x32_bf16 v[56:59], v[44:47], v[20:23], v[56:59]
    s_nop 0
    v_add_f32_dpp v8, v8, v8 quad_perm:[1,0,3,2] row_mask:0xf bank_mask:0xf
    v_mfma_f32_16x16x32_bf16 v[60:63], v[44:47], v[28:31], v[60:63]
    s_nop 0
    v_add_f32_dpp v8, v8, v8 quad_perm:[2,3,0,1] row_mask:0xf bank_mask:0xf
    v_rcp_f32 v8, v8
    s_nop 0
    v_pk_mul_f32 v[64:65], v[64:65], v[8:9] op_sel:[0,0] op_sel_hi:[1,0]
    v_pk_mul_f32 v[48:49], v[48:49], v[64:65] op_sel:[0,0] op_sel_hi:[1,0]
    v_pk_mul_f32 v[50:51], v[50:51], v[64:65] op_sel:[0,0] op_sel_hi:[1,0]
    v_pk_mul_f32 v[56:57], v[56:57], v[64:65] op_sel:[0,0] op_sel_hi:[1,0]
    v_pk_mul_f32 v[58:59], v[58:59], v[64:65] op_sel:[0,0] op_sel_hi:[1,0]
    v_pk_fma_f32 v[48:49], v[52:53], v[64:65], v[48:49] op_sel:[0,1,0] op_sel_hi:[1,1,1]
    v_pk_fma_f32 v[50:51], v[54:55], v[64:65], v[50:51] op_sel:[0,1,0] op_sel_hi:[1,1,1]
    v_pk_fma_f32 v[56:57], v[60:61], v[64:65], v[56:57] op_sel:[0,1,0] op_sel_hi:[1,1,1]
    v_pk_fma_f32 v[58:59], v[62:63], v[64:65], v[58:59] op_sel:[0,1,0] op_sel_hi:[1,1,1]
    v_add_f32_dpp v48, v48, v48 quad_perm:[1,0,3,2] row_mask:0xf bank_mask:0xf
    v_add_f32_dpp v49, v49, v49 quad_perm:[1,0,3,2] row_mask:0xf bank_mask:0xf
    v_add_f32_dpp v50, v50, v50 quad_perm:[1,0,3,2] row_mask:0xf bank_mask:0xf
    v_add_f32_dpp v51, v51, v51 quad_perm:[1,0,3,2] row_mask:0xf bank_mask:0xf
    v_add_f32_dpp v56, v56, v56 quad_perm:[1,0,3,2] row_mask:0xf bank_mask:0xf
    v_add_f32_dpp v57, v57, v57 quad_perm:[1,0,3,2] row_mask:0xf bank_mask:0xf
    v_add_f32_dpp v58, v58, v58 quad_perm:[1,0,3,2] row_mask:0xf bank_mask:0xf
    v_add_f32_dpp v59, v59, v59 quad_perm:[1,0,3,2] row_mask:0xf bank_mask:0xf
    v_add_f32_dpp v48, v48, v48 quad_perm:[2,3,0,1] row_mask:0xf bank_mask:0xf
    v_add_f32_dpp v49, v49, v49 quad_perm:[2,3,0,1] row_mask:0xf bank_mask:0xf
    v_add_f32_dpp v50, v50, v50 quad_perm:[2,3,0,1] row_mask:0xf bank_mask:0xf
    v_add_f32_dpp v51, v51, v51 quad_perm:[2,3,0,1] row_mask:0xf bank_mask:0xf
    v_add_f32_dpp v56, v56, v56 quad_perm:[2,3,0,1] row_mask:0xf bank_mask:0xf
    v_add_f32_dpp v57, v57, v57 quad_perm:[2,3,0,1] row_mask:0xf bank_mask:0xf
    v_add_f32_dpp v58, v58, v58 quad_perm:[2,3,0,1] row_mask:0xf bank_mask:0xf
    v_add_f32_dpp v59, v59, v59 quad_perm:[2,3,0,1] row_mask:0xf bank_mask:0xf
    s_mov_b64 exec, s[96:97]
    ds_write_b128 v156, v[48:51] offset:9216
    ds_write_b128 v156, v[56:59] offset:9280
    s_mov_b64 exec, -1
    s_waitcnt lgkmcnt(0)
L_B5:
    s_barrier
    s_cmp_lg_u32 s3, 4
    s_cbranch_scc1 L_H2
    ds_read_b64 v[16:17], v149 offset:9216
    ds_read_b64 v[18:19], v149 offset:9728
    ds_read_b64 v[20:21], v149 offset:10240
    ds_read_b64 v[22:23], v149 offset:10752
    s_waitcnt lgkmcnt(0)
    v_pk_add_f32 v[16:17], v[16:17], v[18:19]
    v_pk_add_f32 v[20:21], v[20:21], v[22:23]
    v_pk_add_f32 v[32:33], v[16:17], v[20:21]
    v_min_u32 v32, -2, v32
    v_min_u32 v33, -2, v33
    s_cmp_lg_u32 s4, 4
    s_cbranch_scc1 L_h2g
    s_cmp_lg_u32 s1, 0
    s_cbranch_scc1 L_h2g
    buffer_store_dwordx2 v[32:33], v148, s[44:47], s69 offen
    s_branch L_H2
L_h2g:
    buffer_store_dwordx2 v[32:33], v148, s[44:47], s69 offen sc1
L_H2:
    s_cmp_ge_u32 s26, 4
    s_cbranch_scc1 L_fin
L_fseg:
    s_lshl_b32 s8, s26, 15
    s_lshl_b32 s9, s63, 8
    s_add_u32 s8, s8, s9
    s_add_u32 s64, s8, 0x10000
    s_add_u32 s65, s64, 0x2000
    s_add_u32 s66, s64, 0x4000
    s_add_u32 s67, s64, 0x6000
    s_cbranch_execz L_fs_a
    buffer_load_dwordx4 v[16:19], v146, s[44:47], s64 offen sc1
    buffer_load_dwordx4 v[20:23], v146, s[44:47], s65 offen sc1
    buffer_load_dwordx4 v[24:27], v146, s[44:47], s66 offen sc1
    buffer_load_dwordx4 v[28:31], v146, s[44:47], s67 offen sc1
L_fs_a:
    s_mov_b32 s8, 0x3b000000
    s_mov_b32 s9, 0x3b000000
    s_mov_b32 s10, 0x3727c5ac
    s_mov_b32 s60, 0x80000000
    s_mov_b32 s61, 0x80000000
    s_mov_b32 s48, s36
    s_and_b32 s49, s37, 0xffff
    s_mov_b32 s50, 0x1000
    s_mov_b32 s51, 0x20000
    s_mov_b32 s71, 0
L_h2chk:
    s_waitcnt vmcnt(0)
    v_max3_u32 v8, v16, v17, v18
    v_max3_u32 v9, v20, v21, v22
    v_max3_u32 v10, v24, v25, v26
    v_max3_u32 v11, v28, v29, v30
    v_max_u32 v8, v8, v19
    v_max_u32 v9, v9, v23
    v_max_u32 v10, v10, v27
    v_max_u32 v11, v11, v31
    v_max3_u32 v12, v8, v9, v10
    v_max_u32 v12, v12, v11
    v_cmp_eq_u32 vcc, -1, v12
    s_cmp_eq_u64 vcc, 0
    s_cbranch_scc1 L_h2done
    s_add_u32 s71, s71, 1
    s_cmp_ge_u32 s71, 262144
    s_cbranch_scc1 L_h2done
    v_cmp_eq_u32_e64 s[52:53], -1, v8
    v_cmp_eq_u32_e64 s[54:55], -1, v9
    v_cmp_eq_u32_e64 s[56:57], -1, v10
    v_cmp_eq_u32_e64 s[58:59], -1, v11
    s_mov_b64 exec, s[52:53]
    s_cbranch_execz L_h2s0
    buffer_load_dwordx4 v[16:19], v146, s[44:47], s64 offen sc1
L_h2s0:
    s_mov_b64 exec, s[54:55]
    s_cbranch_execz L_h2s1
    buffer_load_dwordx4 v[20:23], v146, s[44:47], s65 offen sc1
L_h2s1:
    s_mov_b64 exec, s[56:57]
    s_cbranch_execz L_h2s2
    buffer_load_dwordx4 v[24:27], v146, s[44:47], s66 offen sc1
L_h2s2:
    s_mov_b64 exec, s[58:59]
    s_cbranch_execz L_h2s3
    buffer_load_dwordx4 v[28:31], v146, s[44:47], s67 offen sc1
L_h2s3:
    s_mov_b64 exec, -1
    s_branch L_h2chk
L_h2done:
    v_lshlrev_b32 v144, 16, v144
    v_pk_add_f32 v[16:17], v[16:17], v[20:21]
    v_pk_add_f32 v[18:19], v[18:19], v[22:23]
    v_pk_add_f32 v[24:25], v[24:25], v[28:29]
    v_pk_add_f32 v[26:27], v[26:27], v[30:31]
    v_pk_add_f32 v[16:17], v[16:17], v[24:25]
    v_pk_add_f32 v[18:19], v[18:19], v[26:27]
    s_nop 0
    v_permlane32_swap_b32 v16, v17
    v_permlane32_swap_b32 v18, v19
    v_add_f32 v16, v16, v17
    v_add_f32 v18, v18, v19
    s_nop 1
    v_permlane16_swap_b32 v16, v18
    v_add_f32 v16, v16, v18
    v_cvt_pk_bf16_f32 v16, v16, v16
    v_and_b32 v16, s42, v16
    v_add_f32 v16, v16, v144
    v_cvt_pk_bf16_f32 v16, v16, v16
    v_and_b32 v13, s42, v16
    v_mul_f32 v19, v13, v13
    v_mov_b32 v18, v13
    s_nop 1
    v_permlane32_swap_b32 v18, v19
    v_add_f32 v18, v18, v19
    s_nop 1
    v_add_f32_dpp v18, v18, v18 row_shr:1 row_mask:0xf bank_mask:0xf bound_ctrl:0
    s_nop 1
    v_add_f32_dpp v18, v18, v18 row_shr:2 row_mask:0xf bank_mask:0xf bound_ctrl:0
    s_nop 1
    v_add_f32_dpp v18, v18, v18 row_shr:4 row_mask:0xf bank_mask:0xf bound_ctrl:0
    s_nop 1
    v_add_f32_dpp v18, v18, v18 row_shr:8 row_mask:0xf bank_mask:0xf bound_ctrl:0
    s_nop 1
    v_add_f32_dpp v18, v18, v18 row_bcast:15 row_mask:0xa bank_mask:0xf
    s_and_b64 exec, s[60:61], s[98:99]
    ds_write_b32 v150, v18 offset:15360
    s_mov_b64 exec, s[98:99]
    s_waitcnt lgkmcnt(0)
    s_cbranch_execz L_fs_b15360
    s_barrier
L_fs_b15360:
    ds_read_b128 v[20:23], v160 offset:15360
    ds_read_b128 v[24:27], v160 offset:15376
    ds_read_b128 v[28:31], v160 offset:15392
    ds_read_b128 v[32:35], v160 offset:15408
    s_waitcnt lgkmcnt(0)
    v_pk_add_f32 v[20:21], v[20:21], v[22:23]
    v_pk_add_f32 v[24:25], v[24:25], v[26:27]
    v_pk_add_f32 v[28:29], v[28:29], v[30:31]
    v_pk_add_f32 v[32:33], v[32:33], v[34:35]
    v_pk_add_f32 v[20:21], v[20:21], v[24:25]
    v_pk_add_f32 v[28:29], v[28:29], v[32:33]
    v_pk_add_f32 v[20:21], v[20:21], v[28:29]
    v_pk_mul_f32 v[20:21], v[20:21], s[8:9]
    v_fma_f32 v21, -v20, v20, v21
    v_max_f32 v21, 0, v21
    v_mov_b32 v24, v20
    v_mov_b32 v25, v21
    v_cvt_pk_bf16_f32 v22, v20, v21
    v_and_b32 v21, s42, v22
    v_lshlrev_b32 v20, 16, v22
    v_add_f32 v21, s10, v21
    v_cvt_pk_bf16_f32 v22, v21, v21
    v_and_b32 v21, s42, v22
    v_sqrt_f32 v21, v21
    s_nop 0
    v_cvt_pk_bf16_f32 v22, v21, v21
    v_and_b32 v21, s42, v22
    v_rcp_f32 v21, v21
    v_sub_f32 v16, v13, v20
    v_cvt_pk_bf16_f32 v16, v16, v16
    v_and_b32 v16, s42, v16
    v_mul_f32 v16, v16, v21
    v_cvt_pk_bf16_f32 v16, v16, v16
    v_and_b32 v16, s42, v16
    v_sub_f32 v24, v24, v20
    v_mul_f32 v25, v25, v21
    v_mul_f32 v20, v24, v21
    v_mul_f32 v21, v25, v21
    v_cvt_pk_bf16_f32 v22, v20, v21
    v_and_b32 v21, s42, v22
    v_lshlrev_b32 v20, 16, v22
    v_add_f32 v21, s10, v21
    v_cvt_pk_bf16_f32 v22, v21, v21
    v_and_b32 v21, s42, v22
    v_sqrt_f32 v21, v21
    s_nop 0
    v_cvt_pk_bf16_f32 v22, v21, v21
    v_and_b32 v21, s42, v22
    v_rcp_f32 v21, v21
    v_sub_f32 v16, v16, v20
    v_cvt_pk_bf16_f32 v16, v16, v16
    v_and_b32 v16, s42, v16
    v_mul_f32 v16, v16, v21
    v_cvt_pk_bf16_f32 v16, v16, v16
    v_and_b32 v17, 0x7fff, v16
    v_subrev_u32 v17, 13824, v17
    v_bfe_u32 v18, v16, 15, 1
    s_movk_i32 s11, 3072
    v_cmp_gt_u32 vcc, s11, v17
    v_mad_u32_u24 v18, v18, s11, v17
    v_lshlrev_b32 v18, 1, v18
    v_cndmask_b32 v18, 0, v18, vcc
    ds_read_u16 v19, v18 offset:16384
    s_mov_b32 s12, 0xffff
    s_waitcnt lgkmcnt(0)
    v_cmp_ne_u32_e64 s[52:53], s12, v19
    v_lshlrev_b32 v19, 16, v19
    v_add_f32 v19, v19, v13
    v_cvt_pk_bf16_f32 v19, v19, v19
    s_and_b64 s[52:53], s[52:53], vcc
    s_mov_b64 exec, s[52:53]
    s_cbranch_execz L_nost
    buffer_store_short v19, v147, s[48:51], s43 offen
L_nost:
    s_andn2_b64 exec, s[98:99], s[52:53]
    s_cbranch_execz L_nomiss
    ds_add_rtn_u32 v17, v163, v162 offset:48
    v_and_b32 v12, s42, v16
    v_or_b32 v12, v12, v147
    s_waitcnt lgkmcnt(0)
    v_lshlrev_b32 v17, 3, v17
    ds_write_b64 v17, v[12:13] offset:11264
    s_waitcnt lgkmcnt(0)
L_nomiss:
    s_mov_b64 exec, s[98:99]
    s_cbranch_execz L_dry_ret
    s_barrier
    s_cmp_lg_u32 s26, 0
    s_cbranch_scc1 L_fin
    s_cmp_lg_u32 s3, 4
    s_cbranch_scc1 L_fin
    s_add_u32 s94, s94, 1
    v_mov_b32 v4, s94
    s_mov_b64 exec, 1
    buffer_store_dword v4, v160, s[44:47], 0 offen offset:0
L_fin:
L_end:
    s_endpgm
.section .rodata,"a"
.p2align 6
.amdhsa_kernel sequential_preLN__sliding_block_cached__mixer_token_mlp__decode_kernel
.amdhsa_next_free_vgpr 168
.amdhsa_next_free_sgpr 102
.amdhsa_accum_offset 168
.amdhsa_group_segment_fixed_size 0
.amdhsa_kernarg_size 104
.amdhsa_user_sgpr_count 2
.amdhsa_user_sgpr_kernarg_segment_ptr 1
.amdhsa_system_sgpr_workgroup_id_x 1
.amdhsa_float_denorm_mode_32 3
.end_amdhsa_kernel
```
